```python
import torch

def _softmax(x, axis=-1):
    return torch.softmax(x, dim=axis)
def _gelu(x):
    return torch.nn.functional.gelu(x, approximate="tanh")
def _silu(x):
    return torch.nn.functional.silu(x)
def _sigmoid(x):
    return torch.sigmoid(x)
def _layernorm(x, axis=-1, eps=1e-5):
    m = x.mean(dim=axis, keepdim=True)
    v = x.var(dim=axis, keepdim=True, unbiased=False)
    return (x - m) / torch.sqrt(v + eps)
def _scatter_add(tgt, idx, src, axis=0):
    return tgt.clone().index_add_(axis, idx, src)
def _segment_sum(src, seg, n):
    out = torch.zeros((n,) + src.shape[1:], dtype=src.dtype)
    return out.index_add_(0, seg, src)
def _pad(x, pw):
    flat = tuple(v for pair in reversed(pw) for v in pair)
    return torch.nn.functional.pad(x, flat)

kernel_name = 'parallel_sum__linear_kernel_hedgehog__moe_arch_mod__prompt'

def setup_inputs():

    _w = (lambda a: (lambda t: t.to(torch.bfloat16) if t.is_floating_point() else t)(torch.as_tensor(a)))
    def _A_setup():
        B, S, D, H = 1, 2048, 640, 32
        Dh = D // H
        return {
            "x": _w((lambda *s: torch.randn(*s, dtype=torch.bfloat16) * 0.05)(B, S, D)),
            "wqkv": _w((lambda *s: torch.randn(*s, dtype=torch.bfloat16) * 0.4)(D, 3 * D)),
            "w_phi": _w((lambda *s: torch.randn(*s, dtype=torch.bfloat16) * 0.4)(H, Dh, Dh) * (Dh ** -0.5)),
            "wo": _w((lambda *s: torch.randn(*s, dtype=torch.bfloat16) * 0.1)(D, D)),
        }
    _A_in = _A_setup()

    def _B_setup():
        B, S, D, F, C = 1, 2048, 640, 1536, 1
        return {
            "x": _w((lambda *s: torch.randn(*s, dtype=torch.bfloat16) * 0.05)(B, S, D)),
            "w_r": _w((lambda *s: torch.randn(*s, dtype=torch.bfloat16) * 0.05)(D)),
            "w_gate": _w((lambda *s: torch.randn(*s, dtype=torch.bfloat16) * 0.05)(D, F)),
            "w_up": _w((lambda *s: torch.randn(*s, dtype=torch.bfloat16) * 0.05)(D, F)),
            "w_down": _w((lambda *s: torch.randn(*s, dtype=torch.bfloat16) * 0.05)(F, D)),
        }
    _B_in = _B_setup()

    return {
        "A_x": _A_in["x"],
        "A_wqkv": _A_in["wqkv"],
        "A_w_phi": _A_in["w_phi"],
        "A_wo": _A_in["wo"],
        "B_x": _B_in["x"],
        "B_w_r": _B_in["w_r"],
        "B_w_gate": _B_in["w_gate"],
        "B_w_up": _B_in["w_up"],
        "B_w_down": _B_in["w_down"],
    }

def reference(A_x, A_wqkv, A_w_phi, A_wo, B_x, B_w_r, B_w_gate, B_w_up, B_w_down):
    def _A_ref(x, wqkv, w_phi, wo):
        B, S, D = x.shape
        H = 32; Dh = D // H
        qkv = (lambda x, *d: x.permute(*d))((x @ wqkv).reshape(B, S, 3, H, Dh), 2, 0, 3, 1, 4)
        q, k, v = qkv[0], qkv[1], qkv[2]
        pq = torch.einsum("bhsd,hdf->bhsf", q, w_phi)
        pk = torch.einsum("bhsd,hdf->bhsf", k, w_phi)
        phi_q = torch.concatenate([_softmax(pq, axis=-1), _softmax(-pq, axis=-1)], axis=-1)
        phi_k = torch.concatenate([_softmax(pk, axis=-1), _softmax(-pk, axis=-1)], axis=-1)
        kv = torch.einsum("bhsf,bhsd->bhfd", phi_k, v)
        z  = torch.einsum("bhsf->bhf", phi_k)
        num = torch.einsum("bhqf,bhfd->bhqd", phi_q, kv)
        den = torch.einsum("bhqf,bhf->bhq", phi_q, z)[..., None] + 1e-6
        o = num / den
        return (lambda x, *d: x.permute(*d))(o, 0, 2, 1, 3).reshape(B, S, D) @ wo

    def _B_ref(x, w_r, w_gate, w_up, w_down):
        B, S, D = x.shape
        C = 1
        r = x @ w_r
        idx = torch.argsort(-r, axis=-1)[:, :C]
        idx_e = (lambda x, n, axis: torch.repeat_interleave(x, n, dim=axis))(idx.reshape(B, C, 1), D, axis=2)
        x_sel = (lambda x, i, axis: torch.take_along_dim(x, i, dim=axis))(x, idx_e, axis=1)
        g = _silu(x_sel @ w_gate)
        u = x_sel @ w_up
        y = (g * u) @ w_down
        r_sel = _sigmoid((lambda x, i, axis: torch.take_along_dim(x, i, dim=axis))(r, idx, axis=1))
        y = y * r_sel.reshape(B, C, 1)
        b_off = (torch.arange(B) * S).reshape(B, 1)
        flat_idx = (idx + b_off).reshape(B * C)
        zero = (x * 0.0).reshape(B * S, D)
        upd = _scatter_add(zero, flat_idx, y.reshape(B * C, D), axis=0)
        return x + upd.reshape(B, S, D)

    x = A_x
    xn = _layernorm(x, axis=-1)
    return x + _A_ref(xn, A_wqkv, A_w_phi, A_wo) + _B_ref(xn, B_w_r, B_w_gate, B_w_up, B_w_down)
```

```asm
; @launch kernel=k0_kernel grid=(256,1,1) block=(512,1,1) lds=4096
; @launch kernel=k1_kernel grid=(256,1,1) block=(256,1,1) lds=131072
; @launch kernel=k2_kernel grid=(112,1,1) block=(256,1,1) lds=16384
; @launch kernel=k3_kernel grid=(256,1,1) block=(256,1,1) lds=88576
.amdgcn_target "amdgcn-amd-amdhsa--gfx950"
.text
.globl k0_kernel
.p2align 8
.type k0_kernel,@function
k0_kernel:
    s_cmp_ge_u32 s2, 256
    s_cbranch_scc1 K0_END
    s_load_dwordx4 s[4:7], s[0:1], 0
    s_load_dwordx4 s[8:11], s[0:1], 16
    s_load_dwordx2 s[12:13], s[0:1], 40
    s_load_dwordx2 s[14:15], s[0:1], 88
    v_and_b32 v1, 63, v0
    v_lshrrev_b32 v4, 6, v0
    v_and_b32 v2, 31, v1
    v_lshrrev_b32 v3, 5, v1
    v_readfirstlane_b32 s30, v4
    v_and_b32 v4, 7, v0
    v_lshrrev_b32 v5, 3, v0
    s_lshl_b32 s31, s2, 3
    v_add_u32 v6, s31, v4
    v_mul_u32_u24 v7, 1280, v6
    v_lshl_add_u32 v7, v5, 4, v7
    v_cmp_gt_u32 vcc, 16, v5
    v_mov_b32 v80, 2130706432
    v_lshlrev_b32 v81, 4, v5
    v_cndmask_b32 v82, v80, v7, vcc
    s_waitcnt lgkmcnt(0)
    s_mov_b32 s16, s4
    s_and_b32 s17, s5, 0xffff
    s_mov_b32 s18, 2621440
    s_mov_b32 s19, 0x00020000
    s_mov_b32 s20, s6
    s_and_b32 s21, s7, 0xffff
    s_mov_b32 s22, 2457600
    s_mov_b32 s23, 0x00020000
    s_mov_b32 s24, s14
    s_and_b32 s25, s15, 0xffff
    s_mov_b32 s26, 20971520
    s_mov_b32 s27, 0x00020000
    s_mov_b32 s36, s8
    s_and_b32 s37, s9, 0xffff
    s_mov_b32 s38, 25600
    s_mov_b32 s39, 0x00020000
    s_mov_b32 s40, s10
    s_and_b32 s41, s11, 0xffff
    s_mov_b32 s42, 819200
    s_mov_b32 s43, 0x00020000
    s_mov_b32 s44, s12
    s_and_b32 s45, s13, 0xffff
    s_mov_b32 s46, 1280
    s_mov_b32 s47, 0x00020000
    buffer_load_dwordx4 v[8:11], v7, s[16:19], 0 offen
    buffer_load_dwordx4 v[12:15], v82, s[16:19], 0 offen offset:1024
    buffer_load_dwordx4 v[20:23], v81, s[44:47], 0 offen
    buffer_load_dwordx4 v[24:27], v81, s[44:47], 0 offen offset:1024
    s_lshr_b32 s32, s30, 2
    s_lshl_b32 s32, s32, 8
    s_add_u32 s32, s32, s2
    s_mov_b32 s59, s32
    s_mul_i32 s33, s32, 205
    s_lshr_b32 s33, s33, 12
    s_mul_i32 s34, s33, 20
    s_sub_u32 s48, s32, s34
    s_lshl_b32 s33, s33, 2
    s_and_b32 s34, s30, 3
    s_add_u32 s33, s33, s34
    s_lshr_b32 s49, s33, 5
    s_and_b32 s50, s33, 31
    v_mul_u32_u24 v83, 3840, v2
    v_cmp_eq_u32 vcc, 0, v3
    s_nop 0
    v_cndmask_b32 v84, v80, v83, vcc
    v_lshl_add_u32 v83, v3, 4, v83
    v_mul_u32_u24 v85, 320, v3
    v_lshl_add_u32 v85, v2, 1, v85
    v_lshlrev_b32 v86, 1, v2
    v_cmp_gt_u32 s[32:33], 20, v2
    s_and_b64 s[34:35], s[32:33], vcc
    v_cndmask_b32 v85, v80, v85, s[32:33]
    v_cndmask_b32 v86, v80, v86, s[34:35]
    s_cmp_ge_u32 s59, 480
    s_cbranch_scc1 K0_NOJL
    s_mul_i32 s32, s48, 122880
    s_mul_i32 s33, s49, 1280
    s_add_u32 s32, s32, s33
    s_mul_i32 s33, s50, 40
    s_add_u32 s32, s32, s33
    buffer_load_dwordx4 v[32:35], v83, s[20:23], s32 offen
    buffer_load_dwordx2 v[36:37], v84, s[20:23], s32 offen offset:32
    s_mul_i32 s33, s50, 800
    buffer_load_ushort v40, v85, s[36:39], s33 offen offset:0
    buffer_load_ushort v41, v85, s[36:39], s33 offen offset:40
    buffer_load_ushort v42, v85, s[36:39], s33 offen offset:80
    buffer_load_ushort v43, v85, s[36:39], s33 offen offset:120
    buffer_load_ushort v44, v85, s[36:39], s33 offen offset:160
    buffer_load_ushort v45, v85, s[36:39], s33 offen offset:200
    buffer_load_ushort v46, v85, s[36:39], s33 offen offset:240
    buffer_load_ushort v47, v85, s[36:39], s33 offen offset:280
    buffer_load_ushort v48, v86, s[36:39], s33 offen offset:640
    buffer_load_ushort v49, v86, s[36:39], s33 offen offset:680
    buffer_load_ushort v50, v86, s[36:39], s33 offen offset:720
    buffer_load_ushort v51, v86, s[36:39], s33 offen offset:760
K0_NOJL:
    s_lshl_b32 s60, s30, 8
    s_add_u32 s60, s60, s2
    s_cmp_ge_u32 s60, 800
    s_cbranch_scc1 K0_NOWOL
    s_mul_i32 s32, s60, 41
    s_lshr_b32 s32, s32, 13
    s_mul_i32 s33, s32, 200
    s_sub_u32 s33, s60, s33
    s_mul_i32 s34, s33, 205
    s_lshr_b32 s34, s34, 11
    s_mul_i32 s35, s34, 10
    s_sub_u32 s35, s33, s35
    v_mul_u32_u24 v87, 12800, v3
    s_lshl_b32 s34, s34, 6
    v_lshl_add_u32 v87, v2, 1, v87
    v_add_u32 v87, s34, v87
    s_lshl_b32 s61, s35, 3
    s_add_u32 s61, s61, 0
    s_mul_i32 s62, s61, 205
    s_lshr_b32 s62, s62, 11
    s_mul_i32 s63, s62, 10
    s_sub_u32 s63, s61, s63
    s_lshl_b32 s64, s32, 3
    s_add_u32 s64, s64, s62
    s_mul_i32 s64, s64, 20
    s_add_u32 s64, s64, s63
    s_mul_i32 s64, s64, 1280
    buffer_load_ushort v72, v87, s[40:43], s64 offen
    s_lshl_b32 s61, s35, 3
    s_add_u32 s61, s61, 1
    s_mul_i32 s62, s61, 205
    s_lshr_b32 s62, s62, 11
    s_mul_i32 s63, s62, 10
    s_sub_u32 s63, s61, s63
    s_lshl_b32 s64, s32, 3
    s_add_u32 s64, s64, s62
    s_mul_i32 s64, s64, 20
    s_add_u32 s64, s64, s63
    s_mul_i32 s64, s64, 1280
    buffer_load_ushort v73, v87, s[40:43], s64 offen
    s_lshl_b32 s61, s35, 3
    s_add_u32 s61, s61, 2
    s_mul_i32 s62, s61, 205
    s_lshr_b32 s62, s62, 11
    s_mul_i32 s63, s62, 10
    s_sub_u32 s63, s61, s63
    s_lshl_b32 s64, s32, 3
    s_add_u32 s64, s64, s62
    s_mul_i32 s64, s64, 20
    s_add_u32 s64, s64, s63
    s_mul_i32 s64, s64, 1280
    buffer_load_ushort v74, v87, s[40:43], s64 offen
    s_lshl_b32 s61, s35, 3
    s_add_u32 s61, s61, 3
    s_mul_i32 s62, s61, 205
    s_lshr_b32 s62, s62, 11
    s_mul_i32 s63, s62, 10
    s_sub_u32 s63, s61, s63
    s_lshl_b32 s64, s32, 3
    s_add_u32 s64, s64, s62
    s_mul_i32 s64, s64, 20
    s_add_u32 s64, s64, s63
    s_mul_i32 s64, s64, 1280
    buffer_load_ushort v75, v87, s[40:43], s64 offen
    s_lshl_b32 s61, s35, 3
    s_add_u32 s61, s61, 4
    s_mul_i32 s62, s61, 205
    s_lshr_b32 s62, s62, 11
    s_mul_i32 s63, s62, 10
    s_sub_u32 s63, s61, s63
    s_lshl_b32 s64, s32, 3
    s_add_u32 s64, s64, s62
    s_mul_i32 s64, s64, 20
    s_add_u32 s64, s64, s63
    s_mul_i32 s64, s64, 1280
    buffer_load_ushort v76, v87, s[40:43], s64 offen
    s_lshl_b32 s61, s35, 3
    s_add_u32 s61, s61, 5
    s_mul_i32 s62, s61, 205
    s_lshr_b32 s62, s62, 11
    s_mul_i32 s63, s62, 10
    s_sub_u32 s63, s61, s63
    s_lshl_b32 s64, s32, 3
    s_add_u32 s64, s64, s62
    s_mul_i32 s64, s64, 20
    s_add_u32 s64, s64, s63
    s_mul_i32 s64, s64, 1280
    buffer_load_ushort v77, v87, s[40:43], s64 offen
    s_lshl_b32 s61, s35, 3
    s_add_u32 s61, s61, 6
    s_mul_i32 s62, s61, 205
    s_lshr_b32 s62, s62, 11
    s_mul_i32 s63, s62, 10
    s_sub_u32 s63, s61, s63
    s_lshl_b32 s64, s32, 3
    s_add_u32 s64, s64, s62
    s_mul_i32 s64, s64, 20
    s_add_u32 s64, s64, s63
    s_mul_i32 s64, s64, 1280
    buffer_load_ushort v78, v87, s[40:43], s64 offen
    s_lshl_b32 s61, s35, 3
    s_add_u32 s61, s61, 7
    s_mul_i32 s62, s61, 205
    s_lshr_b32 s62, s62, 11
    s_mul_i32 s63, s62, 10
    s_sub_u32 s63, s61, s63
    s_lshl_b32 s64, s32, 3
    s_add_u32 s64, s64, s62
    s_mul_i32 s64, s64, 20
    s_add_u32 s64, s64, s63
    s_mul_i32 s64, s64, 1280
    buffer_load_ushort v79, v87, s[40:43], s64 offen
K0_NOWOL:
    s_waitcnt vmcnt(0)
    v_lshlrev_b32 v88, 16, v8
    v_and_b32 v89, 0xffff0000, v8
    v_lshlrev_b32 v112, 16, v20
    v_and_b32 v113, 0xffff0000, v20
    v_lshlrev_b32 v90, 16, v9
    v_and_b32 v91, 0xffff0000, v9
    v_lshlrev_b32 v114, 16, v21
    v_and_b32 v115, 0xffff0000, v21
    v_lshlrev_b32 v92, 16, v10
    v_and_b32 v93, 0xffff0000, v10
    v_lshlrev_b32 v116, 16, v22
    v_and_b32 v117, 0xffff0000, v22
    v_lshlrev_b32 v94, 16, v11
    v_and_b32 v95, 0xffff0000, v11
    v_lshlrev_b32 v118, 16, v23
    v_and_b32 v119, 0xffff0000, v23
    v_lshlrev_b32 v96, 16, v12
    v_and_b32 v97, 0xffff0000, v12
    v_lshlrev_b32 v120, 16, v24
    v_and_b32 v121, 0xffff0000, v24
    v_lshlrev_b32 v98, 16, v13
    v_and_b32 v99, 0xffff0000, v13
    v_lshlrev_b32 v122, 16, v25
    v_and_b32 v123, 0xffff0000, v25
    v_lshlrev_b32 v100, 16, v14
    v_and_b32 v101, 0xffff0000, v14
    v_lshlrev_b32 v124, 16, v26
    v_and_b32 v125, 0xffff0000, v26
    v_lshlrev_b32 v102, 16, v15
    v_and_b32 v103, 0xffff0000, v15
    v_lshlrev_b32 v126, 16, v27
    v_and_b32 v127, 0xffff0000, v27
    v_add_f32 v136, v88, v89
    v_mul_f32 v137, v88, v88
    v_mul_f32 v138, v88, v112
    v_add_f32 v139, v112, v113
    v_fmac_f32 v137, v89, v89
    v_fmac_f32 v138, v89, v113
    v_add_f32 v136, v136, v90
    v_fmac_f32 v137, v90, v90
    v_fmac_f32 v138, v90, v114
    v_add_f32 v139, v139, v114
    v_add_f32 v136, v136, v91
    v_fmac_f32 v137, v91, v91
    v_fmac_f32 v138, v91, v115
    v_add_f32 v139, v139, v115
    v_add_f32 v136, v136, v92
    v_fmac_f32 v137, v92, v92
    v_fmac_f32 v138, v92, v116
    v_add_f32 v139, v139, v116
    v_add_f32 v136, v136, v93
    v_fmac_f32 v137, v93, v93
    v_fmac_f32 v138, v93, v117
    v_add_f32 v139, v139, v117
    v_add_f32 v136, v136, v94
    v_fmac_f32 v137, v94, v94
    v_fmac_f32 v138, v94, v118
    v_add_f32 v139, v139, v118
    v_add_f32 v136, v136, v95
    v_fmac_f32 v137, v95, v95
    v_fmac_f32 v138, v95, v119
    v_add_f32 v139, v139, v119
    v_add_f32 v136, v136, v96
    v_fmac_f32 v137, v96, v96
    v_fmac_f32 v138, v96, v120
    v_add_f32 v139, v139, v120
    v_add_f32 v136, v136, v97
    v_fmac_f32 v137, v97, v97
    v_fmac_f32 v138, v97, v121
    v_add_f32 v139, v139, v121
    v_add_f32 v136, v136, v98
    v_fmac_f32 v137, v98, v98
    v_fmac_f32 v138, v98, v122
    v_add_f32 v139, v139, v122
    v_add_f32 v136, v136, v99
    v_fmac_f32 v137, v99, v99
    v_fmac_f32 v138, v99, v123
    v_add_f32 v139, v139, v123
    v_add_f32 v136, v136, v100
    v_fmac_f32 v137, v100, v100
    v_fmac_f32 v138, v100, v124
    v_add_f32 v139, v139, v124
    v_add_f32 v136, v136, v101
    v_fmac_f32 v137, v101, v101
    v_fmac_f32 v138, v101, v125
    v_add_f32 v139, v139, v125
    v_add_f32 v136, v136, v102
    v_fmac_f32 v137, v102, v102
    v_fmac_f32 v138, v102, v126
    v_add_f32 v139, v139, v126
    v_add_f32 v136, v136, v103
    v_fmac_f32 v137, v103, v103
    v_fmac_f32 v138, v103, v127
    v_add_f32 v139, v139, v127
    v_add_f32_dpp v136, v136, v136 row_ror:8 row_mask:0xf bank_mask:0xf
    v_mov_b32 v140, v136
    v_mov_b32 v141, v136
    s_nop 1
    v_permlane16_swap_b32 v140, v141
    s_nop 1
    v_add_f32 v136, v140, v141
    v_mov_b32 v140, v136
    v_mov_b32 v141, v136
    s_nop 1
    v_permlane32_swap_b32 v140, v141
    s_nop 1
    v_add_f32 v136, v140, v141
    v_add_f32_dpp v137, v137, v137 row_ror:8 row_mask:0xf bank_mask:0xf
    v_mov_b32 v140, v137
    v_mov_b32 v141, v137
    s_nop 1
    v_permlane16_swap_b32 v140, v141
    s_nop 1
    v_add_f32 v137, v140, v141
    v_mov_b32 v140, v137
    v_mov_b32 v141, v137
    s_nop 1
    v_permlane32_swap_b32 v140, v141
    s_nop 1
    v_add_f32 v137, v140, v141
    v_add_f32_dpp v138, v138, v138 row_ror:8 row_mask:0xf bank_mask:0xf
    v_mov_b32 v140, v138
    v_mov_b32 v141, v138
    s_nop 1
    v_permlane16_swap_b32 v140, v141
    s_nop 1
    v_add_f32 v138, v140, v141
    v_mov_b32 v140, v138
    v_mov_b32 v141, v138
    s_nop 1
    v_permlane32_swap_b32 v140, v141
    s_nop 1
    v_add_f32 v138, v140, v141
    v_add_f32_dpp v139, v139, v139 row_ror:8 row_mask:0xf bank_mask:0xf
    v_mov_b32 v140, v139
    v_mov_b32 v141, v139
    s_nop 1
    v_permlane16_swap_b32 v140, v141
    s_nop 1
    v_add_f32 v139, v140, v141
    v_mov_b32 v140, v139
    v_mov_b32 v141, v139
    s_nop 1
    v_permlane32_swap_b32 v140, v141
    s_nop 1
    v_add_f32 v139, v140, v141
    v_lshlrev_b32 v140, 4, v4
    s_lshl_b32 s32, s30, 7
    v_add_u32 v141, s32, v140
    ds_write_b128 v141, v[136:139]
    s_cmp_ge_u32 s59, 480
    s_cbranch_scc1 K0_NOJ
    v_mov_b32 v38, 0
    v_mov_b32 v39, 0
    s_cmp_eq_u32 s49, 2
    s_cbranch_scc1 K0_J_ID
    v_lshl_or_b32 v170, v41, 16, v40
    v_lshl_or_b32 v171, v43, 16, v42
    v_lshl_or_b32 v172, v45, 16, v44
    v_lshl_or_b32 v173, v47, 16, v46
    v_lshl_or_b32 v174, v49, 16, v48
    v_lshl_or_b32 v175, v51, 16, v50
    s_branch K0_J_B
K0_J_ID:
    v_lshlrev_b32 v178, 3, v3
    v_sub_u32 v178, v2, v178
    v_mov_b32 v179, 0x3f80
    v_mov_b32 v180, 0x3f800000
    v_cmp_eq_u32 vcc, 0, v178
    v_cmp_eq_u32 s[32:33], 1, v178
    s_nop 0
    v_cndmask_b32 v170, 0, v179, vcc
    v_cndmask_b32 v181, 0, v180, s[32:33]
    v_or_b32 v170, v170, v181
    v_cmp_eq_u32 vcc, 2, v178
    v_cmp_eq_u32 s[32:33], 3, v178
    s_nop 0
    v_cndmask_b32 v171, 0, v179, vcc
    v_cndmask_b32 v181, 0, v180, s[32:33]
    v_or_b32 v171, v171, v181
    v_cmp_eq_u32 vcc, 4, v178
    v_cmp_eq_u32 s[32:33], 5, v178
    s_nop 0
    v_cndmask_b32 v172, 0, v179, vcc
    v_cndmask_b32 v181, 0, v180, s[32:33]
    v_or_b32 v172, v172, v181
    v_cmp_eq_u32 vcc, 6, v178
    v_cmp_eq_u32 s[32:33], 7, v178
    s_nop 0
    v_cndmask_b32 v173, 0, v179, vcc
    v_cndmask_b32 v181, 0, v180, s[32:33]
    v_or_b32 v173, v173, v181
    v_lshl_add_u32 v178, v3, 6, v2
    v_cmp_eq_u32 vcc, 16, v178
    v_cmp_eq_u32 s[32:33], 17, v178
    s_nop 0
    v_cndmask_b32 v174, 0, v179, vcc
    v_cndmask_b32 v181, 0, v180, s[32:33]
    v_or_b32 v174, v174, v181
    v_cmp_eq_u32 vcc, 18, v178
    v_cmp_eq_u32 s[32:33], 19, v178
    s_nop 0
    v_cndmask_b32 v175, 0, v179, vcc
    v_cndmask_b32 v181, 0, v180, s[32:33]
    v_or_b32 v175, v175, v181
K0_J_B:
    v_mov_b32 v176, 0
    v_mov_b32 v177, 0
    s_nop 1
    v_mfma_f32_32x32x16_bf16 v[184:199], v[32:35], v[170:173], 0
    v_mfma_f32_32x32x16_bf16 v[184:199], v[36:39], v[174:177], v[184:199]
    s_cmp_eq_u32 s49, 1
    s_cselect_b32 s32, 32, 0
    v_add_u32 v178, s32, v2
    v_mov_b32 v179, 20
    s_cmp_eq_u32 s49, 2
    s_cbranch_scc0 K0_J_O
    v_cmp_gt_u32 vcc, 12, v2
    v_add_u32 v178, 20, v2
    v_add_u32 v179, 40, v2
    v_cndmask_b32 v178, v179, v178, vcc
    v_mov_b32 v179, 24
K0_J_O:
    s_and_b32 s32, s50, 1
    s_lshl_b32 s32, s32, 2
    v_lshrrev_b32 v180, 4, v178
    v_lshlrev_b32 v180, 10, v180
    v_bfe_u32 v181, v178, 2, 2
    v_lshlrev_b32 v181, 3, v181
    v_and_b32 v182, 3, v178
    v_add3_u32 v181, v181, v182, s32
    v_lshl_add_u32 v181, v3, 5, v181
    v_lshl_add_u32 v180, v181, 4, v180
    v_cmp_lt_u32 vcc, v2, v179
    s_nop 0
    v_cndmask_b32 v180, v80, v180, vcc
    s_lshr_b32 s32, s50, 1
    s_mul_i32 s32, s32, 40
    s_lshl_b32 s33, s48, 1
    s_add_u32 s32, s32, s33
    s_lshl_b32 s32, s32, 12
    s_add_u32 s32, s32, 13631488
    s_add_u32 s33, s32, 4096
    s_nop 7
    v_cvt_pk_bf16_f32 v200, v184, v185
    v_cvt_pk_bf16_f32 v201, v186, v187
    v_cvt_pk_bf16_f32 v202, v188, v189
    v_cvt_pk_bf16_f32 v203, v190, v191
    v_cvt_pk_bf16_f32 v204, v192, v193
    v_cvt_pk_bf16_f32 v205, v194, v195
    v_cvt_pk_bf16_f32 v206, v196, v197
    v_cvt_pk_bf16_f32 v207, v198, v199
    s_nop 1
    v_permlane32_swap_b32 v200, v202
    v_permlane32_swap_b32 v201, v203
    v_permlane32_swap_b32 v204, v206
    v_permlane32_swap_b32 v205, v207
    s_nop 1
    buffer_store_dwordx4 v[200:203], v180, s[24:27], s32 offen sc0 sc1
    buffer_store_dwordx4 v[204:207], v180, s[24:27], s33 offen sc0 sc1
K0_NOJ:
    s_cmp_ge_u32 s60, 800
    s_cbranch_scc1 K0_NOWO
    v_lshl_or_b32 v208, v73, 16, v72
    v_lshl_or_b32 v209, v75, 16, v74
    v_lshl_or_b32 v210, v77, 16, v76
    v_lshl_or_b32 v211, v79, 16, v78
    v_lshlrev_b32 v212, 4, v1
    s_lshl_b32 s32, s60, 10
    s_add_u32 s32, s32, 8585216
    buffer_store_dwordx4 v[208:211], v212, s[24:27], s32 offen sc0 sc1
K0_NOWO:
    s_waitcnt lgkmcnt(0)
    s_barrier
    ds_read_b128 v[144:147], v140 offset:0
    ds_read_b128 v[148:151], v140 offset:128
    ds_read_b128 v[152:155], v140 offset:256
    ds_read_b128 v[156:159], v140 offset:384
    ds_read_b128 v[160:163], v140 offset:512
    ds_read_b128 v[164:167], v140 offset:640
    ds_read_b128 v[168:171], v140 offset:768
    ds_read_b128 v[172:175], v140 offset:896
    s_waitcnt lgkmcnt(0)
    v_add_f32 v144, v144, v148
    v_add_f32 v152, v152, v156
    v_add_f32 v160, v160, v164
    v_add_f32 v168, v168, v172
    v_add_f32 v144, v144, v152
    v_add_f32 v160, v160, v168
    v_add_f32 v144, v144, v160
    v_add_f32 v145, v145, v149
    v_add_f32 v153, v153, v157
    v_add_f32 v161, v161, v165
    v_add_f32 v169, v169, v173
    v_add_f32 v145, v145, v153
    v_add_f32 v161, v161, v169
    v_add_f32 v145, v145, v161
    v_add_f32 v146, v146, v150
    v_add_f32 v154, v154, v158
    v_add_f32 v162, v162, v166
    v_add_f32 v170, v170, v174
    v_add_f32 v146, v146, v154
    v_add_f32 v162, v162, v170
    v_add_f32 v146, v146, v162
    v_add_f32 v147, v147, v151
    v_add_f32 v155, v155, v159
    v_add_f32 v163, v163, v167
    v_add_f32 v171, v171, v175
    v_add_f32 v147, v147, v155
    v_add_f32 v163, v163, v171
    v_add_f32 v147, v147, v163
    s_mov_b32 s32, 0x3acccccd
    v_mul_f32 v176, s32, v144
    v_mul_f32 v178, s32, v145
    v_fma_f32 v178, -v176, v176, v178
    v_max_f32 v178, 0, v178
    v_cvt_pk_bf16_f32 v176, v176, v176
    v_lshlrev_b32 v176, 16, v176
    v_cvt_pk_bf16_f32 v178, v178, v178
    v_lshlrev_b32 v178, 16, v178
    v_add_f32 v178, 0x3727c5ac, v178
    v_cvt_pk_bf16_f32 v178, v178, v178
    v_lshlrev_b32 v178, 16, v178
    v_sqrt_f32 v178, v178
    s_nop 0
    v_cvt_pk_bf16_f32 v178, v178, v178
    v_lshlrev_b32 v178, 16, v178
    v_rcp_f32 v177, v178
    s_nop 0
    v_fma_f32 v179, -v176, v147, v146
    v_mul_f32 v179, v179, v177
    v_sub_f32 v88, v88, v176
    v_sub_f32 v89, v89, v176
    v_sub_f32 v90, v90, v176
    v_sub_f32 v91, v91, v176
    v_sub_f32 v92, v92, v176
    v_sub_f32 v93, v93, v176
    v_sub_f32 v94, v94, v176
    v_sub_f32 v95, v95, v176
    v_sub_f32 v96, v96, v176
    v_sub_f32 v97, v97, v176
    v_sub_f32 v98, v98, v176
    v_sub_f32 v99, v99, v176
    v_sub_f32 v100, v100, v176
    v_sub_f32 v101, v101, v176
    v_sub_f32 v102, v102, v176
    v_sub_f32 v103, v103, v176
    v_cvt_pk_bf16_f32 v8, v88, v89
    v_lshlrev_b32 v88, 16, v8
    v_and_b32 v89, 0xffff0000, v8
    v_mul_f32 v88, v88, v177
    v_mul_f32 v89, v89, v177
    v_cvt_pk_bf16_f32 v8, v88, v89
    v_cvt_pk_bf16_f32 v9, v90, v91
    v_lshlrev_b32 v90, 16, v9
    v_and_b32 v91, 0xffff0000, v9
    v_mul_f32 v90, v90, v177
    v_mul_f32 v91, v91, v177
    v_cvt_pk_bf16_f32 v9, v90, v91
    v_cvt_pk_bf16_f32 v10, v92, v93
    v_lshlrev_b32 v92, 16, v10
    v_and_b32 v93, 0xffff0000, v10
    v_mul_f32 v92, v92, v177
    v_mul_f32 v93, v93, v177
    v_cvt_pk_bf16_f32 v10, v92, v93
    v_cvt_pk_bf16_f32 v11, v94, v95
    v_lshlrev_b32 v94, 16, v11
    v_and_b32 v95, 0xffff0000, v11
    v_mul_f32 v94, v94, v177
    v_mul_f32 v95, v95, v177
    v_cvt_pk_bf16_f32 v11, v94, v95
    v_cvt_pk_bf16_f32 v12, v96, v97
    v_lshlrev_b32 v96, 16, v12
    v_and_b32 v97, 0xffff0000, v12
    v_mul_f32 v96, v96, v177
    v_mul_f32 v97, v97, v177
    v_cvt_pk_bf16_f32 v12, v96, v97
    v_cvt_pk_bf16_f32 v13, v98, v99
    v_lshlrev_b32 v98, 16, v13
    v_and_b32 v99, 0xffff0000, v13
    v_mul_f32 v98, v98, v177
    v_mul_f32 v99, v99, v177
    v_cvt_pk_bf16_f32 v13, v98, v99
    v_cvt_pk_bf16_f32 v14, v100, v101
    v_lshlrev_b32 v100, 16, v14
    v_and_b32 v101, 0xffff0000, v14
    v_mul_f32 v100, v100, v177
    v_mul_f32 v101, v101, v177
    v_cvt_pk_bf16_f32 v14, v100, v101
    v_cvt_pk_bf16_f32 v15, v102, v103
    v_lshlrev_b32 v102, 16, v15
    v_and_b32 v103, 0xffff0000, v15
    v_mul_f32 v102, v102, v177
    v_mul_f32 v103, v103, v177
    v_cvt_pk_bf16_f32 v15, v102, v103
    v_lshrrev_b32 v180, 5, v6
    v_mul_u32_u24 v180, 40960, v180
    v_and_b32 v181, 31, v6
    v_lshl_add_u32 v180, v181, 4, v180
    v_lshl_add_u32 v180, v5, 9, v180
    v_cmp_gt_u32 vcc, 16, v5
    s_mov_b32 s32, 10485760
    v_cndmask_b32 v181, v80, v180, vcc
    buffer_store_dwordx4 v[8:11], v180, s[24:27], s32 offen sc0 sc1
    s_mov_b32 s33, 10518528
    buffer_store_dwordx4 v[12:15], v181, s[24:27], s33 offen sc0 sc1
    s_cmp_lg_u32 s30, 0
    s_cbranch_scc1 K0_NOKEY
    v_cvt_pk_bf16_f32 v182, v179, v179
    v_and_b32 v182, 0xffff, v182
    v_and_b32 v183, 0x8000, v182
    v_cmp_eq_u32 vcc, 0, v183
    v_mov_b32 v183, 0xffff
    v_mov_b32 v184, 0x8000
    v_cndmask_b32 v183, v183, v184, vcc
    v_xor_b32 v182, v182, v183
    v_lshlrev_b32 v182, 16, v182
    v_sub_u32 v183, 0xffff, v6
    v_or_b32 v182, v182, v183
    s_nop 1
    v_max_u32_dpp v182, v182, v182 quad_perm:[1,0,3,2] row_mask:0xf bank_mask:0xf
    s_nop 1
    v_max_u32_dpp v182, v182, v182 quad_perm:[2,3,0,1] row_mask:0xf bank_mask:0xf
    s_nop 1
    v_max_u32_dpp v182, v182, v182 row_ror:4 row_mask:0xf bank_mask:0xf
    v_lshlrev_b32 v183, 3, v6
    v_mov_b32 v184, v176
    v_mov_b32 v185, v177
    v_cmp_gt_u32 vcc, 8, v1
    s_and_saveexec_b64 s[32:33], vcc
    s_mov_b32 s34, 8388608
    buffer_store_dwordx2 v[184:185], v183, s[24:27], s34 offen sc0 sc1
    v_cmp_eq_u32 vcc, 0, v1
    s_and_b64 exec, exec, vcc
    s_lshl_b32 s34, s2, 2
    s_add_u32 s34, s34, 8404992
    v_mov_b32 v183, 0
    buffer_store_dword v182, v183, s[24:27], s34 offen sc0 sc1
    s_mov_b64 exec, s[32:33]
K0_NOKEY:
K0_END:
    s_endpgm
.globl k1_kernel
.p2align 8
.type k1_kernel,@function
k1_kernel:
    s_cmp_ge_u32 s2, 256
    s_cbranch_scc1 K1_END
    s_load_dwordx4 s[8:11], s[0:1], 48
    s_load_dwordx2 s[4:5], s[0:1], 64
    s_load_dwordx2 s[12:13], s[0:1], 88
    s_and_b32 s14, s2, 7
    s_lshr_b32 s15, s2, 3
    s_and_b32 s28, s14, 1
    s_lshl_b32 s28, s28, 3
    s_and_b32 s29, s15, 7
    s_add_u32 s28, s28, s29
    s_lshr_b32 s29, s14, 1
    s_lshl_b32 s29, s29, 2
    s_lshr_b32 s15, s15, 3
    s_add_u32 s29, s29, s15
    v_lshrrev_b32 v1, 6, v0
    v_and_b32 v2, 63, v0
    v_lshlrev_b32 v8, 4, v2
    v_readfirstlane_b32 s30, v1
    v_and_b32 v3, 31, v2
    v_lshrrev_b32 v4, 5, v2
    v_bfe_u32 v5, v2, 2, 2
    v_and_b32 v6, 3, v2
    v_bfe_u32 v7, v2, 4, 1
    s_mul_i32 s62, s2, 171
    s_lshr_b32 s62, s62, 12
    s_mul_i32 s63, s62, 24
    s_sub_u32 s63, s2, s63
    v_lshrrev_b32 v9, 3, v0
    v_and_b32 v10, 7, v0
    s_lshl_b32 s34, s62, 6
    v_add_u32 v11, s34, v9
    v_mul_u32_u24 v12, 3072, v11
    v_lshl_add_u32 v12, v10, 4, v12
    s_lshl_b32 s34, s63, 7
    v_add_u32 v12, s34, v12
    s_waitcnt lgkmcnt(0)
    s_mov_b32 s24, s12
    s_and_b32 s25, s13, 0xffff
    s_mov_b32 s26, 20971520
    s_mov_b32 s27, 0x00020000
    s_mov_b32 s16, s8
    s_and_b32 s17, s9, 0xffff
    s_mov_b32 s18, 1966080
    s_mov_b32 s19, 0x00020000
    s_mov_b32 s20, s10
    s_and_b32 s21, s11, 0xffff
    s_mov_b32 s22, 1966080
    s_mov_b32 s23, 0x00020000
    s_mov_b32 s36, s4
    s_and_b32 s37, s5, 0xffff
    s_mov_b32 s38, 1966080
    s_mov_b32 s39, 0x00020000
    s_mov_b32 s34, 8404992
    buffer_load_dwordx4 v[116:119], v8, s[24:27], s34 offen
    s_mul_i32 s48, s29, 163840
    s_lshl_b32 s34, s30, 12
    s_add_u32 s48, s48, s34
    s_add_u32 s48, s48, 13631488
    s_lshl_b32 s49, s28, 2
    s_add_u32 s49, s49, s30
    s_mul_i32 s49, s49, 40960
    s_add_u32 s49, s49, 10485760
    s_mov_b32 s50, s34
    s_add_u32 s54, s48, 0
    s_add_u32 m0, s50, 0
    s_nop 0
    buffer_load_dwordx4 v8, s[24:27], s54 offen lds
    s_add_u32 s54, s48, 1024
    s_add_u32 m0, s50, 1024
    s_nop 0
    buffer_load_dwordx4 v8, s[24:27], s54 offen lds
    s_add_u32 s54, s48, 2048
    s_add_u32 m0, s50, 2048
    s_nop 0
    buffer_load_dwordx4 v8, s[24:27], s54 offen lds
    s_add_u32 s54, s48, 3072
    s_add_u32 m0, s50, 3072
    s_nop 0
    buffer_load_dwordx4 v8, s[24:27], s54 offen lds
    s_add_u32 s54, s49, 0
    buffer_load_dwordx4 a[0:3], v8, s[24:27], s54 offen offset:0
    s_add_u32 s54, s49, 0
    buffer_load_dwordx4 a[4:7], v8, s[24:27], s54 offen offset:1024
    s_add_u32 s54, s49, 0
    buffer_load_dwordx4 a[8:11], v8, s[24:27], s54 offen offset:2048
    s_add_u32 s54, s49, 0
    buffer_load_dwordx4 a[12:15], v8, s[24:27], s54 offen offset:3072
    s_add_u32 s54, s48, 16384
    s_add_u32 m0, s50, 16384
    s_nop 0
    buffer_load_dwordx4 v8, s[24:27], s54 offen lds
    s_add_u32 s54, s48, 17408
    s_add_u32 m0, s50, 17408
    s_nop 0
    buffer_load_dwordx4 v8, s[24:27], s54 offen lds
    s_add_u32 s54, s48, 18432
    s_add_u32 m0, s50, 18432
    s_nop 0
    buffer_load_dwordx4 v8, s[24:27], s54 offen lds
    s_add_u32 s54, s48, 19456
    s_add_u32 m0, s50, 19456
    s_nop 0
    buffer_load_dwordx4 v8, s[24:27], s54 offen lds
    s_add_u32 s54, s49, 4096
    buffer_load_dwordx4 a[16:19], v8, s[24:27], s54 offen offset:0
    s_add_u32 s54, s49, 4096
    buffer_load_dwordx4 a[20:23], v8, s[24:27], s54 offen offset:1024
    s_add_u32 s54, s49, 4096
    buffer_load_dwordx4 a[24:27], v8, s[24:27], s54 offen offset:2048
    s_add_u32 s54, s49, 4096
    buffer_load_dwordx4 a[28:31], v8, s[24:27], s54 offen offset:3072
    s_add_u32 s54, s48, 32768
    s_add_u32 m0, s50, 32768
    s_nop 0
    buffer_load_dwordx4 v8, s[24:27], s54 offen lds
    s_add_u32 s54, s48, 33792
    s_add_u32 m0, s50, 33792
    s_nop 0
    buffer_load_dwordx4 v8, s[24:27], s54 offen lds
    s_add_u32 s54, s48, 34816
    s_add_u32 m0, s50, 34816
    s_nop 0
    buffer_load_dwordx4 v8, s[24:27], s54 offen lds
    s_add_u32 s54, s48, 35840
    s_add_u32 m0, s50, 35840
    s_nop 0
    buffer_load_dwordx4 v8, s[24:27], s54 offen lds
    s_add_u32 s54, s49, 8192
    buffer_load_dwordx4 a[32:35], v8, s[24:27], s54 offen offset:0
    s_add_u32 s54, s49, 8192
    buffer_load_dwordx4 a[36:39], v8, s[24:27], s54 offen offset:1024
    s_add_u32 s54, s49, 8192
    buffer_load_dwordx4 a[40:43], v8, s[24:27], s54 offen offset:2048
    s_add_u32 s54, s49, 8192
    buffer_load_dwordx4 a[44:47], v8, s[24:27], s54 offen offset:3072
    v_mov_b32 v13, v8
    v_add_u32 v14, 0x10000, v8
    v_mov_b32 v64, 0
    v_mov_b32 v65, 0
    v_mov_b32 v66, 0
    v_mov_b32 v67, 0
    v_mov_b32 v68, 0
    v_mov_b32 v69, 0
    v_mov_b32 v70, 0
    v_mov_b32 v71, 0
    v_mov_b32 v72, 0
    v_mov_b32 v73, 0
    v_mov_b32 v74, 0
    v_mov_b32 v75, 0
    v_mov_b32 v76, 0
    v_mov_b32 v77, 0
    v_mov_b32 v78, 0
    v_mov_b32 v79, 0
    v_mov_b32 v80, 0
    v_mov_b32 v81, 0
    v_mov_b32 v82, 0
    v_mov_b32 v83, 0
    v_mov_b32 v84, 0
    v_mov_b32 v85, 0
    v_mov_b32 v86, 0
    v_mov_b32 v87, 0
    v_mov_b32 v88, 0
    v_mov_b32 v89, 0
    v_mov_b32 v90, 0
    v_mov_b32 v91, 0
    v_mov_b32 v92, 0
    v_mov_b32 v93, 0
    v_mov_b32 v94, 0
    v_mov_b32 v95, 0
    v_mov_b32 v132, 0
    v_mov_b32 v133, 0
    v_mov_b32 v134, 0
    v_mov_b32 v135, 0
    v_mov_b32 v136, 0
    v_mov_b32 v137, 0
    v_mov_b32 v138, 0
    v_mov_b32 v139, 0
    v_mov_b32 v140, 0
    v_mov_b32 v141, 0
    v_mov_b32 v142, 0
    v_mov_b32 v143, 0
    v_mov_b32 v144, 0
    v_mov_b32 v145, 0
    v_mov_b32 v146, 0
    v_mov_b32 v147, 0
    v_mov_b32 v148, 0
    v_mov_b32 v149, 0
    v_mov_b32 v150, 0
    v_mov_b32 v151, 0
    v_mov_b32 v152, 0
    v_mov_b32 v153, 0
    v_mov_b32 v154, 0
    v_mov_b32 v155, 0
    v_mov_b32 v156, 0
    v_mov_b32 v157, 0
    v_mov_b32 v158, 0
    v_mov_b32 v159, 0
    v_mov_b32 v160, 0
    v_mov_b32 v161, 0
    v_mov_b32 v162, 0
    v_mov_b32 v163, 0
    s_waitcnt vmcnt(24)
    v_max_u32 v116, v116, v117
    v_max_u32 v118, v118, v119
    v_max_u32 v116, v116, v118
    s_nop 1
    v_max_u32_dpp v116, v116, v116 quad_perm:[1,0,3,2] row_mask:0xf bank_mask:0xf
    s_nop 1
    v_max_u32_dpp v116, v116, v116 quad_perm:[2,3,0,1] row_mask:0xf bank_mask:0xf
    s_nop 1
    v_max_u32_dpp v116, v116, v116 row_ror:4 row_mask:0xf bank_mask:0xf
    s_nop 1
    v_max_u32_dpp v116, v116, v116 row_ror:8 row_mask:0xf bank_mask:0xf
    v_mov_b32 v18, v116
    v_mov_b32 v19, v116
    s_nop 1
    v_permlane16_swap_b32 v18, v19
    s_nop 1
    v_max_u32 v116, v18, v19
    v_mov_b32 v18, v116
    v_mov_b32 v19, v116
    s_nop 1
    v_permlane32_swap_b32 v18, v19
    s_nop 1
    v_max_u32 v116, v18, v19
    s_nop 0
    v_readfirstlane_b32 s46, v116
    s_nop 3
    s_and_b32 s47, s46, 0xffff
    s_sub_u32 s47, 0xffff, s47
    s_lshr_b32 s34, s47, 5
    s_mul_i32 s34, s34, 40960
    s_and_b32 s35, s47, 31
    s_lshl_b32 s35, s35, 4
    s_add_u32 s34, s34, s35
    s_add_u32 s34, s34, 10485760
    v_lshrrev_b32 v18, 3, v11
    v_lshlrev_b32 v18, 9, v18
    v_and_b32 v19, 7, v11
    v_lshl_add_u32 v18, v19, 1, v18
    buffer_load_ushort v120, v18, s[24:27], s34 offen
    buffer_load_ushort v121, v18, s[24:27], s34 offen offset:2048
    s_or_b32 s34, s2, s30
    s_cmp_lg_u32 s34, 0
    s_cbranch_scc1 K1_NOFK
    s_mov_b32 s34, 8409088
    v_mov_b32 v18, 0
    buffer_store_dword v116, v18, s[24:27], s34 offen sc0 sc1
K1_NOFK:
    s_waitcnt vmcnt(18)
    s_barrier
    ds_read_b128 v[24:27], v13 offset:0
    ds_read_b128 v[28:31], v13 offset:1024
    ds_read_b128 v[32:35], v13 offset:2048
    ds_read_b128 v[36:39], v13 offset:3072
    ds_read_b128 v[40:43], v13 offset:4096
    ds_read_b128 v[44:47], v13 offset:5120
    ds_read_b128 v[48:51], v13 offset:6144
    ds_read_b128 v[52:55], v13 offset:7168
    s_waitcnt lgkmcnt(4)
    v_mfma_f32_32x32x16_bf16 v[64:79], v[24:27], a[0:3], v[64:79]
    s_add_u32 s54, s48, 49152
    s_add_u32 m0, s50, 49152
    s_nop 0
    buffer_load_dwordx4 v8, s[24:27], s54 offen lds
    v_mfma_f32_32x32x16_bf16 v[80:95], v[28:31], a[0:3], v[80:95]
    v_mfma_f32_32x32x16_bf16 v[132:147], v[32:35], a[0:3], v[132:147]
    s_add_u32 s54, s49, 12288
    buffer_load_dwordx4 a[48:51], v8, s[24:27], s54 offen offset:0
    v_mfma_f32_32x32x16_bf16 v[148:163], v[36:39], a[0:3], v[148:163]
    ds_read_b128 v[24:27], v13 offset:8192
    ds_read_b128 v[28:31], v13 offset:9216
    ds_read_b128 v[32:35], v13 offset:10240
    ds_read_b128 v[36:39], v13 offset:11264
    s_waitcnt lgkmcnt(4)
    v_mfma_f32_32x32x16_bf16 v[64:79], v[40:43], a[4:7], v[64:79]
    s_add_u32 s54, s48, 50176
    s_add_u32 m0, s50, 50176
    s_nop 0
    buffer_load_dwordx4 v8, s[24:27], s54 offen lds
    v_mfma_f32_32x32x16_bf16 v[80:95], v[44:47], a[4:7], v[80:95]
    v_mfma_f32_32x32x16_bf16 v[132:147], v[48:51], a[4:7], v[132:147]
    s_add_u32 s54, s49, 12288
    buffer_load_dwordx4 a[52:55], v8, s[24:27], s54 offen offset:1024
    v_mfma_f32_32x32x16_bf16 v[148:163], v[52:55], a[4:7], v[148:163]
    ds_read_b128 v[40:43], v13 offset:12288
    ds_read_b128 v[44:47], v13 offset:13312
    ds_read_b128 v[48:51], v13 offset:14336
    ds_read_b128 v[52:55], v13 offset:15360
    s_waitcnt lgkmcnt(4)
    v_mfma_f32_32x32x16_bf16 v[64:79], v[24:27], a[8:11], v[64:79]
    s_add_u32 s54, s48, 51200
    s_add_u32 m0, s50, 51200
    s_nop 0
    buffer_load_dwordx4 v8, s[24:27], s54 offen lds
    v_mfma_f32_32x32x16_bf16 v[80:95], v[28:31], a[8:11], v[80:95]
    v_mfma_f32_32x32x16_bf16 v[132:147], v[32:35], a[8:11], v[132:147]
    s_add_u32 s54, s49, 12288
    buffer_load_dwordx4 a[56:59], v8, s[24:27], s54 offen offset:2048
    v_mfma_f32_32x32x16_bf16 v[148:163], v[36:39], a[8:11], v[148:163]
    s_waitcnt vmcnt(16)
    s_barrier
    ds_read_b128 v[24:27], v13 offset:16384
    ds_read_b128 v[28:31], v13 offset:17408
    ds_read_b128 v[32:35], v13 offset:18432
    ds_read_b128 v[36:39], v13 offset:19456
    s_waitcnt lgkmcnt(4)
    v_mfma_f32_32x32x16_bf16 v[64:79], v[40:43], a[12:15], v[64:79]
    s_add_u32 s54, s48, 52224
    s_add_u32 m0, s50, 52224
    s_nop 0
    buffer_load_dwordx4 v8, s[24:27], s54 offen lds
    v_mfma_f32_32x32x16_bf16 v[80:95], v[44:47], a[12:15], v[80:95]
    v_mfma_f32_32x32x16_bf16 v[132:147], v[48:51], a[12:15], v[132:147]
    s_add_u32 s54, s49, 12288
    buffer_load_dwordx4 a[60:63], v8, s[24:27], s54 offen offset:3072
    v_mfma_f32_32x32x16_bf16 v[148:163], v[52:55], a[12:15], v[148:163]
    ds_read_b128 v[40:43], v13 offset:20480
    ds_read_b128 v[44:47], v13 offset:21504
    ds_read_b128 v[48:51], v13 offset:22528
    ds_read_b128 v[52:55], v13 offset:23552
    s_waitcnt lgkmcnt(4)
    v_mfma_f32_32x32x16_bf16 v[64:79], v[24:27], a[16:19], v[64:79]
    s_add_u32 s54, s48, 65536
    s_add_u32 m0, s50, 65536
    s_nop 0
    buffer_load_dwordx4 v8, s[24:27], s54 offen lds
    v_mfma_f32_32x32x16_bf16 v[80:95], v[28:31], a[16:19], v[80:95]
    v_mfma_f32_32x32x16_bf16 v[132:147], v[32:35], a[16:19], v[132:147]
    s_add_u32 s54, s49, 16384
    buffer_load_dwordx4 a[64:67], v8, s[24:27], s54 offen offset:0
    v_mfma_f32_32x32x16_bf16 v[148:163], v[36:39], a[16:19], v[148:163]
    ds_read_b128 v[24:27], v13 offset:24576
    ds_read_b128 v[28:31], v13 offset:25600
    ds_read_b128 v[32:35], v13 offset:26624
    ds_read_b128 v[36:39], v13 offset:27648
    s_waitcnt lgkmcnt(4)
    v_mfma_f32_32x32x16_bf16 v[64:79], v[40:43], a[20:23], v[64:79]
    s_add_u32 s54, s48, 66560
    s_add_u32 m0, s50, 66560
    s_nop 0
    buffer_load_dwordx4 v8, s[24:27], s54 offen lds
    v_mfma_f32_32x32x16_bf16 v[80:95], v[44:47], a[20:23], v[80:95]
    v_mfma_f32_32x32x16_bf16 v[132:147], v[48:51], a[20:23], v[132:147]
    s_add_u32 s54, s49, 16384
    buffer_load_dwordx4 a[68:71], v8, s[24:27], s54 offen offset:1024
    v_mfma_f32_32x32x16_bf16 v[148:163], v[52:55], a[20:23], v[148:163]
    ds_read_b128 v[40:43], v13 offset:28672
    ds_read_b128 v[44:47], v13 offset:29696
    ds_read_b128 v[48:51], v13 offset:30720
    ds_read_b128 v[52:55], v13 offset:31744
    s_waitcnt lgkmcnt(4)
    v_mfma_f32_32x32x16_bf16 v[64:79], v[24:27], a[24:27], v[64:79]
    s_add_u32 s54, s48, 67584
    s_add_u32 m0, s50, 67584
    s_nop 0
    buffer_load_dwordx4 v8, s[24:27], s54 offen lds
    v_mfma_f32_32x32x16_bf16 v[80:95], v[28:31], a[24:27], v[80:95]
    v_mfma_f32_32x32x16_bf16 v[132:147], v[32:35], a[24:27], v[132:147]
    s_add_u32 s54, s49, 16384
    buffer_load_dwordx4 a[72:75], v8, s[24:27], s54 offen offset:2048
    v_mfma_f32_32x32x16_bf16 v[148:163], v[36:39], a[24:27], v[148:163]
    s_waitcnt vmcnt(16)
    s_barrier
    ds_read_b128 v[24:27], v13 offset:32768
    ds_read_b128 v[28:31], v13 offset:33792
    ds_read_b128 v[32:35], v13 offset:34816
    ds_read_b128 v[36:39], v13 offset:35840
    s_waitcnt lgkmcnt(4)
    v_mfma_f32_32x32x16_bf16 v[64:79], v[40:43], a[28:31], v[64:79]
    s_add_u32 s54, s48, 68608
    s_add_u32 m0, s50, 68608
    s_nop 0
    buffer_load_dwordx4 v8, s[24:27], s54 offen lds
    v_mfma_f32_32x32x16_bf16 v[80:95], v[44:47], a[28:31], v[80:95]
    v_mfma_f32_32x32x16_bf16 v[132:147], v[48:51], a[28:31], v[132:147]
    s_add_u32 s54, s49, 16384
    buffer_load_dwordx4 a[76:79], v8, s[24:27], s54 offen offset:3072
    v_mfma_f32_32x32x16_bf16 v[148:163], v[52:55], a[28:31], v[148:163]
    ds_read_b128 v[40:43], v13 offset:36864
    ds_read_b128 v[44:47], v13 offset:37888
    ds_read_b128 v[48:51], v13 offset:38912
    ds_read_b128 v[52:55], v13 offset:39936
    s_waitcnt lgkmcnt(4)
    v_mfma_f32_32x32x16_bf16 v[64:79], v[24:27], a[32:35], v[64:79]
    s_add_u32 s54, s48, 81920
    s_add_u32 m0, s50, 81920
    s_nop 0
    buffer_load_dwordx4 v8, s[24:27], s54 offen lds
    v_mfma_f32_32x32x16_bf16 v[80:95], v[28:31], a[32:35], v[80:95]
    v_mfma_f32_32x32x16_bf16 v[132:147], v[32:35], a[32:35], v[132:147]
    s_add_u32 s54, s49, 20480
    buffer_load_dwordx4 a[80:83], v8, s[24:27], s54 offen offset:0
    v_mfma_f32_32x32x16_bf16 v[148:163], v[36:39], a[32:35], v[148:163]
    ds_read_b128 v[24:27], v13 offset:40960
    ds_read_b128 v[28:31], v13 offset:41984
    ds_read_b128 v[32:35], v13 offset:43008
    ds_read_b128 v[36:39], v13 offset:44032
    s_waitcnt lgkmcnt(4)
    v_mfma_f32_32x32x16_bf16 v[64:79], v[40:43], a[36:39], v[64:79]
    s_add_u32 s54, s48, 82944
    s_add_u32 m0, s50, 82944
    s_nop 0
    buffer_load_dwordx4 v8, s[24:27], s54 offen lds
    v_mfma_f32_32x32x16_bf16 v[80:95], v[44:47], a[36:39], v[80:95]
    v_mfma_f32_32x32x16_bf16 v[132:147], v[48:51], a[36:39], v[132:147]
    s_add_u32 s54, s49, 20480
    buffer_load_dwordx4 a[84:87], v8, s[24:27], s54 offen offset:1024
    v_mfma_f32_32x32x16_bf16 v[148:163], v[52:55], a[36:39], v[148:163]
    ds_read_b128 v[40:43], v13 offset:45056
    ds_read_b128 v[44:47], v13 offset:46080
    ds_read_b128 v[48:51], v13 offset:47104
    ds_read_b128 v[52:55], v13 offset:48128
    s_waitcnt lgkmcnt(4)
    v_mfma_f32_32x32x16_bf16 v[64:79], v[24:27], a[40:43], v[64:79]
    s_add_u32 s54, s48, 83968
    s_add_u32 m0, s50, 83968
    s_nop 0
    buffer_load_dwordx4 v8, s[24:27], s54 offen lds
    v_mfma_f32_32x32x16_bf16 v[80:95], v[28:31], a[40:43], v[80:95]
    v_mfma_f32_32x32x16_bf16 v[132:147], v[32:35], a[40:43], v[132:147]
    s_add_u32 s54, s49, 20480
    buffer_load_dwordx4 a[88:91], v8, s[24:27], s54 offen offset:2048
    v_mfma_f32_32x32x16_bf16 v[148:163], v[36:39], a[40:43], v[148:163]
    s_waitcnt vmcnt(14)
    s_barrier
    ds_read_b128 v[24:27], v13 offset:49152
    ds_read_b128 v[28:31], v13 offset:50176
    ds_read_b128 v[32:35], v13 offset:51200
    ds_read_b128 v[36:39], v13 offset:52224
    s_waitcnt lgkmcnt(4)
    v_mfma_f32_32x32x16_bf16 v[64:79], v[40:43], a[44:47], v[64:79]
    s_add_u32 s54, s48, 84992
    s_add_u32 m0, s50, 84992
    s_nop 0
    buffer_load_dwordx4 v8, s[24:27], s54 offen lds
    v_mfma_f32_32x32x16_bf16 v[80:95], v[44:47], a[44:47], v[80:95]
    v_mfma_f32_32x32x16_bf16 v[132:147], v[48:51], a[44:47], v[132:147]
    s_add_u32 s54, s49, 20480
    buffer_load_dwordx4 a[92:95], v8, s[24:27], s54 offen offset:3072
    v_mfma_f32_32x32x16_bf16 v[148:163], v[52:55], a[44:47], v[148:163]
    ds_read_b128 v[40:43], v13 offset:53248
    ds_read_b128 v[44:47], v13 offset:54272
    ds_read_b128 v[48:51], v13 offset:55296
    ds_read_b128 v[52:55], v13 offset:56320
    s_waitcnt lgkmcnt(4)
    v_mfma_f32_32x32x16_bf16 v[64:79], v[24:27], a[48:51], v[64:79]
    s_add_u32 s54, s48, 98304
    s_add_u32 m0, s50, 98304
    s_nop 0
    buffer_load_dwordx4 v8, s[24:27], s54 offen lds
    v_mfma_f32_32x32x16_bf16 v[80:95], v[28:31], a[48:51], v[80:95]
    v_mfma_f32_32x32x16_bf16 v[132:147], v[32:35], a[48:51], v[132:147]
    s_add_u32 s54, s49, 24576
    buffer_load_dwordx4 a[96:99], v8, s[24:27], s54 offen offset:0
    v_mfma_f32_32x32x16_bf16 v[148:163], v[36:39], a[48:51], v[148:163]
    ds_read_b128 v[24:27], v13 offset:57344
    ds_read_b128 v[28:31], v13 offset:58368
    ds_read_b128 v[32:35], v13 offset:59392
    ds_read_b128 v[36:39], v13 offset:60416
    s_waitcnt lgkmcnt(4)
    v_mfma_f32_32x32x16_bf16 v[64:79], v[40:43], a[52:55], v[64:79]
    s_add_u32 s54, s48, 99328
    s_add_u32 m0, s50, 99328
    s_nop 0
    buffer_load_dwordx4 v8, s[24:27], s54 offen lds
    v_mfma_f32_32x32x16_bf16 v[80:95], v[44:47], a[52:55], v[80:95]
    v_mfma_f32_32x32x16_bf16 v[132:147], v[48:51], a[52:55], v[132:147]
    s_add_u32 s54, s49, 24576
    buffer_load_dwordx4 a[100:103], v8, s[24:27], s54 offen offset:1024
    v_mfma_f32_32x32x16_bf16 v[148:163], v[52:55], a[52:55], v[148:163]
    ds_read_b128 v[40:43], v13 offset:61440
    ds_read_b128 v[44:47], v13 offset:62464
    ds_read_b128 v[48:51], v13 offset:63488
    ds_read_b128 v[52:55], v13 offset:64512
    s_waitcnt lgkmcnt(4)
    v_mfma_f32_32x32x16_bf16 v[64:79], v[24:27], a[56:59], v[64:79]
    s_add_u32 s54, s48, 100352
    s_add_u32 m0, s50, 100352
    s_nop 0
    buffer_load_dwordx4 v8, s[24:27], s54 offen lds
    v_mfma_f32_32x32x16_bf16 v[80:95], v[28:31], a[56:59], v[80:95]
    v_mfma_f32_32x32x16_bf16 v[132:147], v[32:35], a[56:59], v[132:147]
    s_add_u32 s54, s49, 24576
    buffer_load_dwordx4 a[104:107], v8, s[24:27], s54 offen offset:2048
    v_mfma_f32_32x32x16_bf16 v[148:163], v[36:39], a[56:59], v[148:163]
    s_waitcnt vmcnt(14)
    s_barrier
    ds_read_b128 v[24:27], v14 offset:0
    ds_read_b128 v[28:31], v14 offset:1024
    ds_read_b128 v[32:35], v14 offset:2048
    ds_read_b128 v[36:39], v14 offset:3072
    s_waitcnt lgkmcnt(4)
    v_mfma_f32_32x32x16_bf16 v[64:79], v[40:43], a[60:63], v[64:79]
    s_add_u32 s54, s48, 101376
    s_add_u32 m0, s50, 101376
    s_nop 0
    buffer_load_dwordx4 v8, s[24:27], s54 offen lds
    v_mfma_f32_32x32x16_bf16 v[80:95], v[44:47], a[60:63], v[80:95]
    v_mfma_f32_32x32x16_bf16 v[132:147], v[48:51], a[60:63], v[132:147]
    s_add_u32 s54, s49, 24576
    buffer_load_dwordx4 a[108:111], v8, s[24:27], s54 offen offset:3072
    v_mfma_f32_32x32x16_bf16 v[148:163], v[52:55], a[60:63], v[148:163]
    ds_read_b128 v[40:43], v14 offset:4096
    ds_read_b128 v[44:47], v14 offset:5120
    ds_read_b128 v[48:51], v14 offset:6144
    ds_read_b128 v[52:55], v14 offset:7168
    s_waitcnt lgkmcnt(4)
    v_mfma_f32_32x32x16_bf16 v[64:79], v[24:27], a[64:67], v[64:79]
    s_add_u32 s54, s48, 114688
    s_add_u32 m0, s50, 114688
    s_nop 0
    buffer_load_dwordx4 v8, s[24:27], s54 offen lds
    v_mfma_f32_32x32x16_bf16 v[80:95], v[28:31], a[64:67], v[80:95]
    v_mfma_f32_32x32x16_bf16 v[132:147], v[32:35], a[64:67], v[132:147]
    s_add_u32 s54, s49, 28672
    buffer_load_dwordx4 a[112:115], v8, s[24:27], s54 offen offset:0
    v_mfma_f32_32x32x16_bf16 v[148:163], v[36:39], a[64:67], v[148:163]
    ds_read_b128 v[24:27], v14 offset:8192
    ds_read_b128 v[28:31], v14 offset:9216
    ds_read_b128 v[32:35], v14 offset:10240
    ds_read_b128 v[36:39], v14 offset:11264
    s_waitcnt lgkmcnt(4)
    v_mfma_f32_32x32x16_bf16 v[64:79], v[40:43], a[68:71], v[64:79]
    s_add_u32 s54, s48, 115712
    s_add_u32 m0, s50, 115712
    s_nop 0
    buffer_load_dwordx4 v8, s[24:27], s54 offen lds
    v_mfma_f32_32x32x16_bf16 v[80:95], v[44:47], a[68:71], v[80:95]
    v_mfma_f32_32x32x16_bf16 v[132:147], v[48:51], a[68:71], v[132:147]
    s_add_u32 s54, s49, 28672
    buffer_load_dwordx4 a[116:119], v8, s[24:27], s54 offen offset:1024
    v_mfma_f32_32x32x16_bf16 v[148:163], v[52:55], a[68:71], v[148:163]
    ds_read_b128 v[40:43], v14 offset:12288
    ds_read_b128 v[44:47], v14 offset:13312
    ds_read_b128 v[48:51], v14 offset:14336
    ds_read_b128 v[52:55], v14 offset:15360
    s_waitcnt lgkmcnt(4)
    v_mfma_f32_32x32x16_bf16 v[64:79], v[24:27], a[72:75], v[64:79]
    s_add_u32 s54, s48, 116736
    s_add_u32 m0, s50, 116736
    s_nop 0
    buffer_load_dwordx4 v8, s[24:27], s54 offen lds
    v_mfma_f32_32x32x16_bf16 v[80:95], v[28:31], a[72:75], v[80:95]
    v_mfma_f32_32x32x16_bf16 v[132:147], v[32:35], a[72:75], v[132:147]
    s_add_u32 s54, s49, 28672
    buffer_load_dwordx4 a[120:123], v8, s[24:27], s54 offen offset:2048
    v_mfma_f32_32x32x16_bf16 v[148:163], v[36:39], a[72:75], v[148:163]
    s_waitcnt vmcnt(14)
    s_barrier
    ds_read_b128 v[24:27], v14 offset:16384
    ds_read_b128 v[28:31], v14 offset:17408
    ds_read_b128 v[32:35], v14 offset:18432
    ds_read_b128 v[36:39], v14 offset:19456
    s_waitcnt lgkmcnt(4)
    v_mfma_f32_32x32x16_bf16 v[64:79], v[40:43], a[76:79], v[64:79]
    s_add_u32 s54, s48, 117760
    s_add_u32 m0, s50, 117760
    s_nop 0
    buffer_load_dwordx4 v8, s[24:27], s54 offen lds
    v_mfma_f32_32x32x16_bf16 v[80:95], v[44:47], a[76:79], v[80:95]
    v_mfma_f32_32x32x16_bf16 v[132:147], v[48:51], a[76:79], v[132:147]
    s_add_u32 s54, s49, 28672
    buffer_load_dwordx4 a[124:127], v8, s[24:27], s54 offen offset:3072
    v_mfma_f32_32x32x16_bf16 v[148:163], v[52:55], a[76:79], v[148:163]
    ds_read_b128 v[40:43], v14 offset:20480
    ds_read_b128 v[44:47], v14 offset:21504
    ds_read_b128 v[48:51], v14 offset:22528
    ds_read_b128 v[52:55], v14 offset:23552
    s_waitcnt lgkmcnt(4)
    v_mfma_f32_32x32x16_bf16 v[64:79], v[24:27], a[80:83], v[64:79]
    s_add_u32 s54, s48, 131072
    s_add_u32 m0, s50, 0
    s_nop 0
    buffer_load_dwordx4 v8, s[24:27], s54 offen lds
    v_mfma_f32_32x32x16_bf16 v[80:95], v[28:31], a[80:83], v[80:95]
    v_mfma_f32_32x32x16_bf16 v[132:147], v[32:35], a[80:83], v[132:147]
    s_add_u32 s54, s49, 32768
    buffer_load_dwordx4 a[128:131], v8, s[24:27], s54 offen offset:0
    v_mfma_f32_32x32x16_bf16 v[148:163], v[36:39], a[80:83], v[148:163]
    ds_read_b128 v[24:27], v14 offset:24576
    ds_read_b128 v[28:31], v14 offset:25600
    ds_read_b128 v[32:35], v14 offset:26624
    ds_read_b128 v[36:39], v14 offset:27648
    s_waitcnt lgkmcnt(4)
    v_mfma_f32_32x32x16_bf16 v[64:79], v[40:43], a[84:87], v[64:79]
    s_add_u32 s54, s48, 132096
    s_add_u32 m0, s50, 1024
    s_nop 0
    buffer_load_dwordx4 v8, s[24:27], s54 offen lds
    v_mfma_f32_32x32x16_bf16 v[80:95], v[44:47], a[84:87], v[80:95]
    v_mfma_f32_32x32x16_bf16 v[132:147], v[48:51], a[84:87], v[132:147]
    s_add_u32 s54, s49, 32768
    buffer_load_dwordx4 a[132:135], v8, s[24:27], s54 offen offset:1024
    v_mfma_f32_32x32x16_bf16 v[148:163], v[52:55], a[84:87], v[148:163]
    ds_read_b128 v[40:43], v14 offset:28672
    ds_read_b128 v[44:47], v14 offset:29696
    ds_read_b128 v[48:51], v14 offset:30720
    ds_read_b128 v[52:55], v14 offset:31744
    s_waitcnt lgkmcnt(4)
    v_mfma_f32_32x32x16_bf16 v[64:79], v[24:27], a[88:91], v[64:79]
    s_add_u32 s54, s48, 133120
    s_add_u32 m0, s50, 2048
    s_nop 0
    buffer_load_dwordx4 v8, s[24:27], s54 offen lds
    v_mfma_f32_32x32x16_bf16 v[80:95], v[28:31], a[88:91], v[80:95]
    v_mfma_f32_32x32x16_bf16 v[132:147], v[32:35], a[88:91], v[132:147]
    s_add_u32 s54, s49, 32768
    buffer_load_dwordx4 a[136:139], v8, s[24:27], s54 offen offset:2048
    v_mfma_f32_32x32x16_bf16 v[148:163], v[36:39], a[88:91], v[148:163]
    s_waitcnt vmcnt(14)
    s_barrier
    ds_read_b128 v[24:27], v14 offset:32768
    ds_read_b128 v[28:31], v14 offset:33792
    ds_read_b128 v[32:35], v14 offset:34816
    ds_read_b128 v[36:39], v14 offset:35840
    s_waitcnt lgkmcnt(4)
    v_mfma_f32_32x32x16_bf16 v[64:79], v[40:43], a[92:95], v[64:79]
    s_add_u32 s54, s48, 134144
    s_add_u32 m0, s50, 3072
    s_nop 0
    buffer_load_dwordx4 v8, s[24:27], s54 offen lds
    v_mfma_f32_32x32x16_bf16 v[80:95], v[44:47], a[92:95], v[80:95]
    v_mfma_f32_32x32x16_bf16 v[132:147], v[48:51], a[92:95], v[132:147]
    s_add_u32 s54, s49, 32768
    buffer_load_dwordx4 a[140:143], v8, s[24:27], s54 offen offset:3072
    v_mfma_f32_32x32x16_bf16 v[148:163], v[52:55], a[92:95], v[148:163]
    ds_read_b128 v[40:43], v14 offset:36864
    ds_read_b128 v[44:47], v14 offset:37888
    ds_read_b128 v[48:51], v14 offset:38912
    ds_read_b128 v[52:55], v14 offset:39936
    s_waitcnt lgkmcnt(4)
    v_mfma_f32_32x32x16_bf16 v[64:79], v[24:27], a[96:99], v[64:79]
    s_add_u32 s54, s48, 147456
    s_add_u32 m0, s50, 16384
    s_nop 0
    buffer_load_dwordx4 v8, s[24:27], s54 offen lds
    v_mfma_f32_32x32x16_bf16 v[80:95], v[28:31], a[96:99], v[80:95]
    v_mfma_f32_32x32x16_bf16 v[132:147], v[32:35], a[96:99], v[132:147]
    s_add_u32 s54, s49, 36864
    buffer_load_dwordx4 a[144:147], v8, s[24:27], s54 offen offset:0
    v_mfma_f32_32x32x16_bf16 v[148:163], v[36:39], a[96:99], v[148:163]
    ds_read_b128 v[24:27], v14 offset:40960
    ds_read_b128 v[28:31], v14 offset:41984
    ds_read_b128 v[32:35], v14 offset:43008
    ds_read_b128 v[36:39], v14 offset:44032
    s_waitcnt lgkmcnt(4)
    v_mfma_f32_32x32x16_bf16 v[64:79], v[40:43], a[100:103], v[64:79]
    s_add_u32 s54, s48, 148480
    s_add_u32 m0, s50, 17408
    s_nop 0
    buffer_load_dwordx4 v8, s[24:27], s54 offen lds
    v_mfma_f32_32x32x16_bf16 v[80:95], v[44:47], a[100:103], v[80:95]
    v_mfma_f32_32x32x16_bf16 v[132:147], v[48:51], a[100:103], v[132:147]
    s_add_u32 s54, s49, 36864
    buffer_load_dwordx4 a[148:151], v8, s[24:27], s54 offen offset:1024
    v_mfma_f32_32x32x16_bf16 v[148:163], v[52:55], a[100:103], v[148:163]
    ds_read_b128 v[40:43], v14 offset:45056
    ds_read_b128 v[44:47], v14 offset:46080
    ds_read_b128 v[48:51], v14 offset:47104
    ds_read_b128 v[52:55], v14 offset:48128
    s_waitcnt lgkmcnt(4)
    v_mfma_f32_32x32x16_bf16 v[64:79], v[24:27], a[104:107], v[64:79]
    s_add_u32 s54, s48, 149504
    s_add_u32 m0, s50, 18432
    s_nop 0
    buffer_load_dwordx4 v8, s[24:27], s54 offen lds
    v_mfma_f32_32x32x16_bf16 v[80:95], v[28:31], a[104:107], v[80:95]
    v_mfma_f32_32x32x16_bf16 v[132:147], v[32:35], a[104:107], v[132:147]
    s_add_u32 s54, s49, 36864
    buffer_load_dwordx4 a[152:155], v8, s[24:27], s54 offen offset:2048
    v_mfma_f32_32x32x16_bf16 v[148:163], v[36:39], a[104:107], v[148:163]
    s_waitcnt vmcnt(14)
    s_barrier
    ds_read_b128 v[24:27], v14 offset:49152
    ds_read_b128 v[28:31], v14 offset:50176
    ds_read_b128 v[32:35], v14 offset:51200
    ds_read_b128 v[36:39], v14 offset:52224
    s_waitcnt lgkmcnt(4)
    v_mfma_f32_32x32x16_bf16 v[64:79], v[40:43], a[108:111], v[64:79]
    s_add_u32 s54, s48, 150528
    s_add_u32 m0, s50, 19456
    s_nop 0
    buffer_load_dwordx4 v8, s[24:27], s54 offen lds
    v_mfma_f32_32x32x16_bf16 v[80:95], v[44:47], a[108:111], v[80:95]
    v_mfma_f32_32x32x16_bf16 v[132:147], v[48:51], a[108:111], v[132:147]
    s_add_u32 s54, s49, 36864
    buffer_load_dwordx4 a[156:159], v8, s[24:27], s54 offen offset:3072
    v_mfma_f32_32x32x16_bf16 v[148:163], v[52:55], a[108:111], v[148:163]
    s_mov_b32 s34, 0
    buffer_load_dwordx4 v[100:103], v12, s[16:19], s34 offen
    buffer_load_dwordx4 v[108:111], v12, s[20:23], s34 offen
    s_mov_b32 s34, 98304
    buffer_load_dwordx4 v[104:107], v12, s[16:19], s34 offen
    buffer_load_dwordx4 v[112:115], v12, s[20:23], s34 offen
    s_mul_i32 s34, s2, 7680
    v_lshlrev_b32 v122, 4, v0
    buffer_load_dwordx4 v[124:127], v122, s[36:39], s34 offen
    s_add_u32 s34, s34, 3584
    buffer_load_dwordx4 v[128:131], v122, s[36:39], s34 offen
    ds_read_b128 v[40:43], v14 offset:53248
    ds_read_b128 v[44:47], v14 offset:54272
    ds_read_b128 v[48:51], v14 offset:55296
    ds_read_b128 v[52:55], v14 offset:56320
    s_waitcnt lgkmcnt(4)
    v_mfma_f32_32x32x16_bf16 v[64:79], v[24:27], a[112:115], v[64:79]
    v_mfma_f32_32x32x16_bf16 v[80:95], v[28:31], a[112:115], v[80:95]
    v_mfma_f32_32x32x16_bf16 v[132:147], v[32:35], a[112:115], v[132:147]
    v_mfma_f32_32x32x16_bf16 v[148:163], v[36:39], a[112:115], v[148:163]
    ds_read_b128 v[24:27], v14 offset:57344
    ds_read_b128 v[28:31], v14 offset:58368
    ds_read_b128 v[32:35], v14 offset:59392
    ds_read_b128 v[36:39], v14 offset:60416
    s_waitcnt lgkmcnt(4)
    v_mfma_f32_32x32x16_bf16 v[64:79], v[40:43], a[116:119], v[64:79]
    v_mfma_f32_32x32x16_bf16 v[80:95], v[44:47], a[116:119], v[80:95]
    v_mfma_f32_32x32x16_bf16 v[132:147], v[48:51], a[116:119], v[132:147]
    v_mfma_f32_32x32x16_bf16 v[148:163], v[52:55], a[116:119], v[148:163]
    ds_read_b128 v[40:43], v14 offset:61440
    ds_read_b128 v[44:47], v14 offset:62464
    ds_read_b128 v[48:51], v14 offset:63488
    ds_read_b128 v[52:55], v14 offset:64512
    s_waitcnt lgkmcnt(4)
    v_mfma_f32_32x32x16_bf16 v[64:79], v[24:27], a[120:123], v[64:79]
    v_mfma_f32_32x32x16_bf16 v[80:95], v[28:31], a[120:123], v[80:95]
    v_mfma_f32_32x32x16_bf16 v[132:147], v[32:35], a[120:123], v[132:147]
    v_mfma_f32_32x32x16_bf16 v[148:163], v[36:39], a[120:123], v[148:163]
    s_waitcnt vmcnt(14)
    s_barrier
    ds_read_b128 v[24:27], v13 offset:0
    ds_read_b128 v[28:31], v13 offset:1024
    ds_read_b128 v[32:35], v13 offset:2048
    ds_read_b128 v[36:39], v13 offset:3072
    s_waitcnt lgkmcnt(4)
    v_mfma_f32_32x32x16_bf16 v[64:79], v[40:43], a[124:127], v[64:79]
    v_mfma_f32_32x32x16_bf16 v[80:95], v[44:47], a[124:127], v[80:95]
    v_mfma_f32_32x32x16_bf16 v[132:147], v[48:51], a[124:127], v[132:147]
    v_mfma_f32_32x32x16_bf16 v[148:163], v[52:55], a[124:127], v[148:163]
    ds_read_b128 v[40:43], v13 offset:4096
    ds_read_b128 v[44:47], v13 offset:5120
    ds_read_b128 v[48:51], v13 offset:6144
    ds_read_b128 v[52:55], v13 offset:7168
    s_waitcnt lgkmcnt(4)
    v_mfma_f32_32x32x16_bf16 v[64:79], v[24:27], a[128:131], v[64:79]
    v_mfma_f32_32x32x16_bf16 v[80:95], v[28:31], a[128:131], v[80:95]
    v_mfma_f32_32x32x16_bf16 v[132:147], v[32:35], a[128:131], v[132:147]
    v_mfma_f32_32x32x16_bf16 v[148:163], v[36:39], a[128:131], v[148:163]
    ds_read_b128 v[24:27], v13 offset:8192
    ds_read_b128 v[28:31], v13 offset:9216
    ds_read_b128 v[32:35], v13 offset:10240
    ds_read_b128 v[36:39], v13 offset:11264
    s_waitcnt lgkmcnt(4)
    v_mfma_f32_32x32x16_bf16 v[64:79], v[40:43], a[132:135], v[64:79]
    v_mfma_f32_32x32x16_bf16 v[80:95], v[44:47], a[132:135], v[80:95]
    v_mfma_f32_32x32x16_bf16 v[132:147], v[48:51], a[132:135], v[132:147]
    v_mfma_f32_32x32x16_bf16 v[148:163], v[52:55], a[132:135], v[148:163]
    ds_read_b128 v[40:43], v13 offset:12288
    ds_read_b128 v[44:47], v13 offset:13312
    ds_read_b128 v[48:51], v13 offset:14336
    ds_read_b128 v[52:55], v13 offset:15360
    s_waitcnt lgkmcnt(4)
    v_mfma_f32_32x32x16_bf16 v[64:79], v[24:27], a[136:139], v[64:79]
    v_mfma_f32_32x32x16_bf16 v[80:95], v[28:31], a[136:139], v[80:95]
    v_mfma_f32_32x32x16_bf16 v[132:147], v[32:35], a[136:139], v[132:147]
    v_mfma_f32_32x32x16_bf16 v[148:163], v[36:39], a[136:139], v[148:163]
    s_waitcnt vmcnt(6)
    s_barrier
    ds_read_b128 v[24:27], v13 offset:16384
    ds_read_b128 v[28:31], v13 offset:17408
    ds_read_b128 v[32:35], v13 offset:18432
    ds_read_b128 v[36:39], v13 offset:19456
    s_waitcnt lgkmcnt(4)
    v_mfma_f32_32x32x16_bf16 v[64:79], v[40:43], a[140:143], v[64:79]
    v_mfma_f32_32x32x16_bf16 v[80:95], v[44:47], a[140:143], v[80:95]
    v_mfma_f32_32x32x16_bf16 v[132:147], v[48:51], a[140:143], v[132:147]
    v_mfma_f32_32x32x16_bf16 v[148:163], v[52:55], a[140:143], v[148:163]
    ds_read_b128 v[40:43], v13 offset:20480
    ds_read_b128 v[44:47], v13 offset:21504
    ds_read_b128 v[48:51], v13 offset:22528
    ds_read_b128 v[52:55], v13 offset:23552
    s_waitcnt lgkmcnt(4)
    v_mfma_f32_32x32x16_bf16 v[64:79], v[24:27], a[144:147], v[64:79]
    v_mfma_f32_32x32x16_bf16 v[80:95], v[28:31], a[144:147], v[80:95]
    v_mfma_f32_32x32x16_bf16 v[132:147], v[32:35], a[144:147], v[132:147]
    v_mfma_f32_32x32x16_bf16 v[148:163], v[36:39], a[144:147], v[148:163]
    ds_read_b128 v[24:27], v13 offset:24576
    ds_read_b128 v[28:31], v13 offset:25600
    ds_read_b128 v[32:35], v13 offset:26624
    ds_read_b128 v[36:39], v13 offset:27648
    s_waitcnt lgkmcnt(4)
    v_mfma_f32_32x32x16_bf16 v[64:79], v[40:43], a[148:151], v[64:79]
    v_mfma_f32_32x32x16_bf16 v[80:95], v[44:47], a[148:151], v[80:95]
    v_mfma_f32_32x32x16_bf16 v[132:147], v[48:51], a[148:151], v[132:147]
    v_mfma_f32_32x32x16_bf16 v[148:163], v[52:55], a[148:151], v[148:163]
    ds_read_b128 v[40:43], v13 offset:28672
    ds_read_b128 v[44:47], v13 offset:29696
    ds_read_b128 v[48:51], v13 offset:30720
    ds_read_b128 v[52:55], v13 offset:31744
    s_waitcnt lgkmcnt(4)
    v_mfma_f32_32x32x16_bf16 v[64:79], v[24:27], a[152:155], v[64:79]
    v_mfma_f32_32x32x16_bf16 v[80:95], v[28:31], a[152:155], v[80:95]
    v_mfma_f32_32x32x16_bf16 v[132:147], v[32:35], a[152:155], v[132:147]
    v_mfma_f32_32x32x16_bf16 v[148:163], v[36:39], a[152:155], v[148:163]
    s_waitcnt lgkmcnt(0)
    v_mfma_f32_32x32x16_bf16 v[64:79], v[40:43], a[156:159], v[64:79]
    v_mfma_f32_32x32x16_bf16 v[80:95], v[44:47], a[156:159], v[80:95]
    v_mfma_f32_32x32x16_bf16 v[132:147], v[48:51], a[156:159], v[132:147]
    v_mfma_f32_32x32x16_bf16 v[148:163], v[52:55], a[156:159], v[148:163]
    s_barrier
    s_nop 7
    s_lshl_b32 s34, s30, 5
    v_add_u32 v17, s34, v3
    v_cvt_pk_bf16_f32 v24, v84, v85
    v_cvt_pk_bf16_f32 v25, v86, v87
    v_cvt_pk_bf16_f32 v26, v88, v89
    v_cvt_pk_bf16_f32 v27, v90, v91
    v_cvt_pk_bf16_f32 v28, v92, v93
    v_cvt_pk_bf16_f32 v29, v94, v95
    v_cvt_pk_bf16_f32 v30, v152, v153
    v_cvt_pk_bf16_f32 v31, v154, v155
    v_cvt_pk_bf16_f32 v32, v156, v157
    v_cvt_pk_bf16_f32 v33, v158, v159
    v_mov_b32 v34, 0x3f80
    v_mov_b32 v35, 0
    v_mul_u32_u24 v9, 192, v17
    v_lshl_add_u32 v10, v4, 6, v9
    v_add_u32 v10, 32768, v10
    ds_write_b128 v10, v[24:27]
    ds_write_b128 v10, v[28:31] offset:16
    ds_write_b128 v10, v[32:35] offset:32
    v_max3_f32 v204, v64, v65, v66
    v_min3_f32 v206, v64, v65, v66
    v_max3_f32 v204, v204, v67, v68
    v_min3_f32 v206, v206, v67, v68
    v_max3_f32 v204, v204, v69, v70
    v_min3_f32 v206, v206, v69, v70
    v_max3_f32 v204, v204, v71, v72
    v_min3_f32 v206, v206, v71, v72
    v_max3_f32 v204, v204, v73, v74
    v_min3_f32 v206, v206, v73, v74
    v_max3_f32 v204, v204, v75, v76
    v_min3_f32 v206, v206, v75, v76
    v_max3_f32 v204, v204, v77, v78
    v_min3_f32 v206, v206, v77, v78
    v_max3_f32 v204, v204, v79, v80
    v_min3_f32 v206, v206, v79, v80
    v_max3_f32 v204, v204, v81, v82
    v_min3_f32 v206, v206, v81, v82
    v_max_f32 v204, v204, v83
    v_min_f32 v206, v206, v83
    s_mov_b32 s60, 0x3fb8aa3b
    s_mov_b32 s61, 0x3fb8aa3b
    v_mul_f32 v204, s60, v204
    v_mul_f32 v206, s60, v206
    v_pk_fma_f32 v[164:165], v[64:65], s[60:61], v[204:205] op_sel_hi:[1,1,0] neg_lo:[0,0,1] neg_hi:[0,0,1]
    v_pk_fma_f32 v[184:185], v[64:65], s[60:61], v[206:207] op_sel_hi:[1,1,0] neg_lo:[0,1,0] neg_hi:[0,1,0]
    v_pk_fma_f32 v[166:167], v[66:67], s[60:61], v[204:205] op_sel_hi:[1,1,0] neg_lo:[0,0,1] neg_hi:[0,0,1]
    v_pk_fma_f32 v[186:187], v[66:67], s[60:61], v[206:207] op_sel_hi:[1,1,0] neg_lo:[0,1,0] neg_hi:[0,1,0]
    v_pk_fma_f32 v[168:169], v[68:69], s[60:61], v[204:205] op_sel_hi:[1,1,0] neg_lo:[0,0,1] neg_hi:[0,0,1]
    v_pk_fma_f32 v[188:189], v[68:69], s[60:61], v[206:207] op_sel_hi:[1,1,0] neg_lo:[0,1,0] neg_hi:[0,1,0]
    v_pk_fma_f32 v[170:171], v[70:71], s[60:61], v[204:205] op_sel_hi:[1,1,0] neg_lo:[0,0,1] neg_hi:[0,0,1]
    v_pk_fma_f32 v[190:191], v[70:71], s[60:61], v[206:207] op_sel_hi:[1,1,0] neg_lo:[0,1,0] neg_hi:[0,1,0]
    v_pk_fma_f32 v[172:173], v[72:73], s[60:61], v[204:205] op_sel_hi:[1,1,0] neg_lo:[0,0,1] neg_hi:[0,0,1]
    v_pk_fma_f32 v[192:193], v[72:73], s[60:61], v[206:207] op_sel_hi:[1,1,0] neg_lo:[0,1,0] neg_hi:[0,1,0]
    v_pk_fma_f32 v[174:175], v[74:75], s[60:61], v[204:205] op_sel_hi:[1,1,0] neg_lo:[0,0,1] neg_hi:[0,0,1]
    v_pk_fma_f32 v[194:195], v[74:75], s[60:61], v[206:207] op_sel_hi:[1,1,0] neg_lo:[0,1,0] neg_hi:[0,1,0]
    v_pk_fma_f32 v[176:177], v[76:77], s[60:61], v[204:205] op_sel_hi:[1,1,0] neg_lo:[0,0,1] neg_hi:[0,0,1]
    v_pk_fma_f32 v[196:197], v[76:77], s[60:61], v[206:207] op_sel_hi:[1,1,0] neg_lo:[0,1,0] neg_hi:[0,1,0]
    v_pk_fma_f32 v[178:179], v[78:79], s[60:61], v[204:205] op_sel_hi:[1,1,0] neg_lo:[0,0,1] neg_hi:[0,0,1]
    v_pk_fma_f32 v[198:199], v[78:79], s[60:61], v[206:207] op_sel_hi:[1,1,0] neg_lo:[0,1,0] neg_hi:[0,1,0]
    v_pk_fma_f32 v[180:181], v[80:81], s[60:61], v[204:205] op_sel_hi:[1,1,0] neg_lo:[0,0,1] neg_hi:[0,0,1]
    v_pk_fma_f32 v[200:201], v[80:81], s[60:61], v[206:207] op_sel_hi:[1,1,0] neg_lo:[0,1,0] neg_hi:[0,1,0]
    v_pk_fma_f32 v[182:183], v[82:83], s[60:61], v[204:205] op_sel_hi:[1,1,0] neg_lo:[0,0,1] neg_hi:[0,0,1]
    v_pk_fma_f32 v[202:203], v[82:83], s[60:61], v[206:207] op_sel_hi:[1,1,0] neg_lo:[0,1,0] neg_hi:[0,1,0]
    v_exp_f32 v164, v164
    v_exp_f32 v165, v165
    v_exp_f32 v166, v166
    v_exp_f32 v167, v167
    v_exp_f32 v168, v168
    v_exp_f32 v169, v169
    v_exp_f32 v170, v170
    v_exp_f32 v171, v171
    v_exp_f32 v172, v172
    v_exp_f32 v173, v173
    v_exp_f32 v174, v174
    v_exp_f32 v175, v175
    v_exp_f32 v176, v176
    v_exp_f32 v177, v177
    v_exp_f32 v178, v178
    v_exp_f32 v179, v179
    v_exp_f32 v180, v180
    v_exp_f32 v181, v181
    v_exp_f32 v182, v182
    v_exp_f32 v183, v183
    v_exp_f32 v184, v184
    v_exp_f32 v185, v185
    v_exp_f32 v186, v186
    v_exp_f32 v187, v187
    v_exp_f32 v188, v188
    v_exp_f32 v189, v189
    v_exp_f32 v190, v190
    v_exp_f32 v191, v191
    v_exp_f32 v192, v192
    v_exp_f32 v193, v193
    v_exp_f32 v194, v194
    v_exp_f32 v195, v195
    v_exp_f32 v196, v196
    v_exp_f32 v197, v197
    v_exp_f32 v198, v198
    v_exp_f32 v199, v199
    v_exp_f32 v200, v200
    v_exp_f32 v201, v201
    v_exp_f32 v202, v202
    v_exp_f32 v203, v203
    s_nop 0
    v_pk_add_f32 v[208:209], v[164:165], v[166:167]
    v_pk_add_f32 v[212:213], v[168:169], v[170:171]
    v_pk_add_f32 v[208:209], v[208:209], v[172:173]
    v_pk_add_f32 v[212:213], v[212:213], v[174:175]
    v_pk_add_f32 v[208:209], v[208:209], v[176:177]
    v_pk_add_f32 v[212:213], v[212:213], v[178:179]
    v_pk_add_f32 v[208:209], v[208:209], v[180:181]
    v_pk_add_f32 v[212:213], v[212:213], v[182:183]
    v_pk_add_f32 v[208:209], v[208:209], v[212:213]
    v_add_f32 v208, v208, v209
    v_pk_add_f32 v[210:211], v[184:185], v[186:187]
    v_pk_add_f32 v[214:215], v[188:189], v[190:191]
    v_pk_add_f32 v[210:211], v[210:211], v[192:193]
    v_pk_add_f32 v[214:215], v[214:215], v[194:195]
    v_pk_add_f32 v[210:211], v[210:211], v[196:197]
    v_pk_add_f32 v[214:215], v[214:215], v[198:199]
    v_pk_add_f32 v[210:211], v[210:211], v[200:201]
    v_pk_add_f32 v[214:215], v[214:215], v[202:203]
    v_pk_add_f32 v[210:211], v[210:211], v[214:215]
    v_add_f32 v210, v210, v211
    v_rcp_f32 v208, v208
    v_rcp_f32 v210, v210
    s_nop 0
    v_pk_mul_f32 v[164:165], v[164:165], v[208:209] op_sel_hi:[1,0]
    v_pk_mul_f32 v[184:185], v[184:185], v[210:211] op_sel_hi:[1,0]
    v_pk_mul_f32 v[166:167], v[166:167], v[208:209] op_sel_hi:[1,0]
    v_pk_mul_f32 v[186:187], v[186:187], v[210:211] op_sel_hi:[1,0]
    v_pk_mul_f32 v[168:169], v[168:169], v[208:209] op_sel_hi:[1,0]
    v_pk_mul_f32 v[188:189], v[188:189], v[210:211] op_sel_hi:[1,0]
    v_pk_mul_f32 v[170:171], v[170:171], v[208:209] op_sel_hi:[1,0]
    v_pk_mul_f32 v[190:191], v[190:191], v[210:211] op_sel_hi:[1,0]
    v_pk_mul_f32 v[172:173], v[172:173], v[208:209] op_sel_hi:[1,0]
    v_pk_mul_f32 v[192:193], v[192:193], v[210:211] op_sel_hi:[1,0]
    v_pk_mul_f32 v[174:175], v[174:175], v[208:209] op_sel_hi:[1,0]
    v_pk_mul_f32 v[194:195], v[194:195], v[210:211] op_sel_hi:[1,0]
    v_pk_mul_f32 v[176:177], v[176:177], v[208:209] op_sel_hi:[1,0]
    v_pk_mul_f32 v[196:197], v[196:197], v[210:211] op_sel_hi:[1,0]
    v_pk_mul_f32 v[178:179], v[178:179], v[208:209] op_sel_hi:[1,0]
    v_pk_mul_f32 v[198:199], v[198:199], v[210:211] op_sel_hi:[1,0]
    v_pk_mul_f32 v[180:181], v[180:181], v[208:209] op_sel_hi:[1,0]
    v_pk_mul_f32 v[200:201], v[200:201], v[210:211] op_sel_hi:[1,0]
    v_pk_mul_f32 v[182:183], v[182:183], v[208:209] op_sel_hi:[1,0]
    v_pk_mul_f32 v[202:203], v[202:203], v[210:211] op_sel_hi:[1,0]
    v_cvt_pk_bf16_f32 v216, v164, v165
    v_cvt_pk_bf16_f32 v217, v166, v167
    v_cvt_pk_bf16_f32 v218, v168, v169
    v_cvt_pk_bf16_f32 v219, v170, v171
    v_cvt_pk_bf16_f32 v220, v172, v173
    v_cvt_pk_bf16_f32 v221, v174, v175
    v_cvt_pk_bf16_f32 v222, v176, v177
    v_cvt_pk_bf16_f32 v223, v178, v179
    v_cvt_pk_bf16_f32 v224, v180, v181
    v_cvt_pk_bf16_f32 v225, v182, v183
    v_cvt_pk_bf16_f32 v226, v184, v185
    v_cvt_pk_bf16_f32 v227, v186, v187
    v_cvt_pk_bf16_f32 v228, v188, v189
    v_cvt_pk_bf16_f32 v229, v190, v191
    v_cvt_pk_bf16_f32 v230, v192, v193
    v_cvt_pk_bf16_f32 v231, v194, v195
    v_cvt_pk_bf16_f32 v232, v196, v197
    v_cvt_pk_bf16_f32 v233, v198, v199
    v_cvt_pk_bf16_f32 v234, v200, v201
    v_cvt_pk_bf16_f32 v235, v202, v203
    s_lshl_b32 s34, s28, 2
    s_add_u32 s34, s34, s30
    s_lshl_b32 s34, s34, 4
    s_add_u32 s34, s34, s29
    s_mul_i32 s34, s34, 5120
    v_mul_u32_u24 v12, 2560, v4
    v_lshl_add_u32 v12, v3, 4, v12
    buffer_store_dwordx4 v[216:219], v12, s[24:27], s34 offen offset:0 sc0 sc1
    buffer_store_dwordx4 v[220:223], v12, s[24:27], s34 offen offset:512 sc0 sc1
    buffer_store_dwordx4 v[224:227], v12, s[24:27], s34 offen offset:1024 sc0 sc1
    buffer_store_dwordx4 v[228:231], v12, s[24:27], s34 offen offset:1536 sc0 sc1
    buffer_store_dwordx4 v[232:235], v12, s[24:27], s34 offen offset:2048 sc0 sc1
    v_max3_f32 v204, v132, v133, v134
    v_min3_f32 v206, v132, v133, v134
    v_max3_f32 v204, v204, v135, v136
    v_min3_f32 v206, v206, v135, v136
    v_max3_f32 v204, v204, v137, v138
    v_min3_f32 v206, v206, v137, v138
    v_max3_f32 v204, v204, v139, v140
    v_min3_f32 v206, v206, v139, v140
    v_max3_f32 v204, v204, v141, v142
    v_min3_f32 v206, v206, v141, v142
    v_max3_f32 v204, v204, v143, v144
    v_min3_f32 v206, v206, v143, v144
    v_max3_f32 v204, v204, v145, v146
    v_min3_f32 v206, v206, v145, v146
    v_max3_f32 v204, v204, v147, v148
    v_min3_f32 v206, v206, v147, v148
    v_max3_f32 v204, v204, v149, v150
    v_min3_f32 v206, v206, v149, v150
    v_max_f32 v204, v204, v151
    v_min_f32 v206, v206, v151
    s_mov_b32 s60, 0x3fb8aa3b
    s_mov_b32 s61, 0x3fb8aa3b
    v_mul_f32 v204, s60, v204
    v_mul_f32 v206, s60, v206
    v_pk_fma_f32 v[164:165], v[132:133], s[60:61], v[204:205] op_sel_hi:[1,1,0] neg_lo:[0,0,1] neg_hi:[0,0,1]
    v_pk_fma_f32 v[184:185], v[132:133], s[60:61], v[206:207] op_sel_hi:[1,1,0] neg_lo:[0,1,0] neg_hi:[0,1,0]
    v_pk_fma_f32 v[166:167], v[134:135], s[60:61], v[204:205] op_sel_hi:[1,1,0] neg_lo:[0,0,1] neg_hi:[0,0,1]
    v_pk_fma_f32 v[186:187], v[134:135], s[60:61], v[206:207] op_sel_hi:[1,1,0] neg_lo:[0,1,0] neg_hi:[0,1,0]
    v_pk_fma_f32 v[168:169], v[136:137], s[60:61], v[204:205] op_sel_hi:[1,1,0] neg_lo:[0,0,1] neg_hi:[0,0,1]
    v_pk_fma_f32 v[188:189], v[136:137], s[60:61], v[206:207] op_sel_hi:[1,1,0] neg_lo:[0,1,0] neg_hi:[0,1,0]
    v_pk_fma_f32 v[170:171], v[138:139], s[60:61], v[204:205] op_sel_hi:[1,1,0] neg_lo:[0,0,1] neg_hi:[0,0,1]
    v_pk_fma_f32 v[190:191], v[138:139], s[60:61], v[206:207] op_sel_hi:[1,1,0] neg_lo:[0,1,0] neg_hi:[0,1,0]
    v_pk_fma_f32 v[172:173], v[140:141], s[60:61], v[204:205] op_sel_hi:[1,1,0] neg_lo:[0,0,1] neg_hi:[0,0,1]
    v_pk_fma_f32 v[192:193], v[140:141], s[60:61], v[206:207] op_sel_hi:[1,1,0] neg_lo:[0,1,0] neg_hi:[0,1,0]
    v_pk_fma_f32 v[174:175], v[142:143], s[60:61], v[204:205] op_sel_hi:[1,1,0] neg_lo:[0,0,1] neg_hi:[0,0,1]
    v_pk_fma_f32 v[194:195], v[142:143], s[60:61], v[206:207] op_sel_hi:[1,1,0] neg_lo:[0,1,0] neg_hi:[0,1,0]
    v_pk_fma_f32 v[176:177], v[144:145], s[60:61], v[204:205] op_sel_hi:[1,1,0] neg_lo:[0,0,1] neg_hi:[0,0,1]
    v_pk_fma_f32 v[196:197], v[144:145], s[60:61], v[206:207] op_sel_hi:[1,1,0] neg_lo:[0,1,0] neg_hi:[0,1,0]
    v_pk_fma_f32 v[178:179], v[146:147], s[60:61], v[204:205] op_sel_hi:[1,1,0] neg_lo:[0,0,1] neg_hi:[0,0,1]
    v_pk_fma_f32 v[198:199], v[146:147], s[60:61], v[206:207] op_sel_hi:[1,1,0] neg_lo:[0,1,0] neg_hi:[0,1,0]
    v_pk_fma_f32 v[180:181], v[148:149], s[60:61], v[204:205] op_sel_hi:[1,1,0] neg_lo:[0,0,1] neg_hi:[0,0,1]
    v_pk_fma_f32 v[200:201], v[148:149], s[60:61], v[206:207] op_sel_hi:[1,1,0] neg_lo:[0,1,0] neg_hi:[0,1,0]
    v_pk_fma_f32 v[182:183], v[150:151], s[60:61], v[204:205] op_sel_hi:[1,1,0] neg_lo:[0,0,1] neg_hi:[0,0,1]
    v_pk_fma_f32 v[202:203], v[150:151], s[60:61], v[206:207] op_sel_hi:[1,1,0] neg_lo:[0,1,0] neg_hi:[0,1,0]
    v_exp_f32 v164, v164
    v_exp_f32 v165, v165
    v_exp_f32 v166, v166
    v_exp_f32 v167, v167
    v_exp_f32 v168, v168
    v_exp_f32 v169, v169
    v_exp_f32 v170, v170
    v_exp_f32 v171, v171
    v_exp_f32 v172, v172
    v_exp_f32 v173, v173
    v_exp_f32 v174, v174
    v_exp_f32 v175, v175
    v_exp_f32 v176, v176
    v_exp_f32 v177, v177
    v_exp_f32 v178, v178
    v_exp_f32 v179, v179
    v_exp_f32 v180, v180
    v_exp_f32 v181, v181
    v_exp_f32 v182, v182
    v_exp_f32 v183, v183
    v_exp_f32 v184, v184
    v_exp_f32 v185, v185
    v_exp_f32 v186, v186
    v_exp_f32 v187, v187
    v_exp_f32 v188, v188
    v_exp_f32 v189, v189
    v_exp_f32 v190, v190
    v_exp_f32 v191, v191
    v_exp_f32 v192, v192
    v_exp_f32 v193, v193
    v_exp_f32 v194, v194
    v_exp_f32 v195, v195
    v_exp_f32 v196, v196
    v_exp_f32 v197, v197
    v_exp_f32 v198, v198
    v_exp_f32 v199, v199
    v_exp_f32 v200, v200
    v_exp_f32 v201, v201
    v_exp_f32 v202, v202
    v_exp_f32 v203, v203
    s_nop 0
    v_pk_add_f32 v[208:209], v[164:165], v[166:167]
    v_pk_add_f32 v[212:213], v[168:169], v[170:171]
    v_pk_add_f32 v[208:209], v[208:209], v[172:173]
    v_pk_add_f32 v[212:213], v[212:213], v[174:175]
    v_pk_add_f32 v[208:209], v[208:209], v[176:177]
    v_pk_add_f32 v[212:213], v[212:213], v[178:179]
    v_pk_add_f32 v[208:209], v[208:209], v[180:181]
    v_pk_add_f32 v[212:213], v[212:213], v[182:183]
    v_pk_add_f32 v[208:209], v[208:209], v[212:213]
    v_add_f32 v208, v208, v209
    v_pk_add_f32 v[210:211], v[184:185], v[186:187]
    v_pk_add_f32 v[214:215], v[188:189], v[190:191]
    v_pk_add_f32 v[210:211], v[210:211], v[192:193]
    v_pk_add_f32 v[214:215], v[214:215], v[194:195]
    v_pk_add_f32 v[210:211], v[210:211], v[196:197]
    v_pk_add_f32 v[214:215], v[214:215], v[198:199]
    v_pk_add_f32 v[210:211], v[210:211], v[200:201]
    v_pk_add_f32 v[214:215], v[214:215], v[202:203]
    v_pk_add_f32 v[210:211], v[210:211], v[214:215]
    v_add_f32 v210, v210, v211
    v_rcp_f32 v208, v208
    v_rcp_f32 v210, v210
    s_nop 0
    v_pk_mul_f32 v[164:165], v[164:165], v[208:209] op_sel_hi:[1,0]
    v_pk_mul_f32 v[184:185], v[184:185], v[210:211] op_sel_hi:[1,0]
    v_pk_mul_f32 v[166:167], v[166:167], v[208:209] op_sel_hi:[1,0]
    v_pk_mul_f32 v[186:187], v[186:187], v[210:211] op_sel_hi:[1,0]
    v_pk_mul_f32 v[168:169], v[168:169], v[208:209] op_sel_hi:[1,0]
    v_pk_mul_f32 v[188:189], v[188:189], v[210:211] op_sel_hi:[1,0]
    v_pk_mul_f32 v[170:171], v[170:171], v[208:209] op_sel_hi:[1,0]
    v_pk_mul_f32 v[190:191], v[190:191], v[210:211] op_sel_hi:[1,0]
    v_pk_mul_f32 v[172:173], v[172:173], v[208:209] op_sel_hi:[1,0]
    v_pk_mul_f32 v[192:193], v[192:193], v[210:211] op_sel_hi:[1,0]
    v_pk_mul_f32 v[174:175], v[174:175], v[208:209] op_sel_hi:[1,0]
    v_pk_mul_f32 v[194:195], v[194:195], v[210:211] op_sel_hi:[1,0]
    v_pk_mul_f32 v[176:177], v[176:177], v[208:209] op_sel_hi:[1,0]
    v_pk_mul_f32 v[196:197], v[196:197], v[210:211] op_sel_hi:[1,0]
    v_pk_mul_f32 v[178:179], v[178:179], v[208:209] op_sel_hi:[1,0]
    v_pk_mul_f32 v[198:199], v[198:199], v[210:211] op_sel_hi:[1,0]
    v_pk_mul_f32 v[180:181], v[180:181], v[208:209] op_sel_hi:[1,0]
    v_pk_mul_f32 v[200:201], v[200:201], v[210:211] op_sel_hi:[1,0]
    v_pk_mul_f32 v[182:183], v[182:183], v[208:209] op_sel_hi:[1,0]
    v_pk_mul_f32 v[202:203], v[202:203], v[210:211] op_sel_hi:[1,0]
    v_cvt_pk_bf16_f32 v36, v164, v165
    v_cvt_pk_bf16_f32 v37, v166, v167
    v_cvt_pk_bf16_f32 v38, v168, v169
    v_cvt_pk_bf16_f32 v39, v170, v171
    v_cvt_pk_bf16_f32 v40, v172, v173
    v_cvt_pk_bf16_f32 v41, v174, v175
    v_cvt_pk_bf16_f32 v42, v176, v177
    v_cvt_pk_bf16_f32 v43, v178, v179
    v_cvt_pk_bf16_f32 v44, v180, v181
    v_cvt_pk_bf16_f32 v45, v182, v183
    v_cvt_pk_bf16_f32 v46, v184, v185
    v_cvt_pk_bf16_f32 v47, v186, v187
    v_cvt_pk_bf16_f32 v48, v188, v189
    v_cvt_pk_bf16_f32 v49, v190, v191
    v_cvt_pk_bf16_f32 v50, v192, v193
    v_cvt_pk_bf16_f32 v51, v194, v195
    v_cvt_pk_bf16_f32 v52, v196, v197
    v_cvt_pk_bf16_f32 v53, v198, v199
    v_cvt_pk_bf16_f32 v54, v200, v201
    v_cvt_pk_bf16_f32 v55, v202, v203
    v_mul_u32_u24 v12, 80, v4
    v_add_u32 v12, v12, v9
    ds_write_b128 v12, v[36:39] offset:0
    ds_write_b128 v12, v[40:43] offset:16
    ds_write_b128 v12, v[44:47] offset:32
    ds_write_b128 v12, v[48:51] offset:48
    ds_write_b128 v12, v[52:55] offset:64
    s_waitcnt vmcnt(5)
    v_lshlrev_b32 v120, 16, v120
    v_lshlrev_b32 v121, 16, v121
    v_lshlrev_b32 v148, 16, v100
    v_and_b32 v149, 0xffff0000, v100
    v_lshlrev_b32 v150, 16, v104
    v_and_b32 v151, 0xffff0000, v104
    v_mul_f32 v132, v148, v120
    v_mul_f32 v133, v149, v120
    v_fmac_f32 v132, v150, v121
    v_fmac_f32 v133, v151, v121
    v_lshlrev_b32 v148, 16, v101
    v_and_b32 v149, 0xffff0000, v101
    v_lshlrev_b32 v150, 16, v105
    v_and_b32 v151, 0xffff0000, v105
    v_mul_f32 v134, v148, v120
    v_mul_f32 v135, v149, v120
    v_fmac_f32 v134, v150, v121
    v_fmac_f32 v135, v151, v121
    v_lshlrev_b32 v148, 16, v102
    v_and_b32 v149, 0xffff0000, v102
    v_lshlrev_b32 v150, 16, v106
    v_and_b32 v151, 0xffff0000, v106
    v_mul_f32 v136, v148, v120
    v_mul_f32 v137, v149, v120
    v_fmac_f32 v136, v150, v121
    v_fmac_f32 v137, v151, v121
    v_lshlrev_b32 v148, 16, v103
    v_and_b32 v149, 0xffff0000, v103
    v_lshlrev_b32 v150, 16, v107
    v_and_b32 v151, 0xffff0000, v107
    v_mul_f32 v138, v148, v120
    v_mul_f32 v139, v149, v120
    v_fmac_f32 v138, v150, v121
    v_fmac_f32 v139, v151, v121
    v_lshlrev_b32 v148, 16, v108
    v_and_b32 v149, 0xffff0000, v108
    v_lshlrev_b32 v150, 16, v112
    v_and_b32 v151, 0xffff0000, v112
    v_mul_f32 v140, v148, v120
    v_mul_f32 v141, v149, v120
    v_fmac_f32 v140, v150, v121
    v_fmac_f32 v141, v151, v121
    v_lshlrev_b32 v148, 16, v109
    v_and_b32 v149, 0xffff0000, v109
    v_lshlrev_b32 v150, 16, v113
    v_and_b32 v151, 0xffff0000, v113
    v_mul_f32 v142, v148, v120
    v_mul_f32 v143, v149, v120
    v_fmac_f32 v142, v150, v121
    v_fmac_f32 v143, v151, v121
    v_lshlrev_b32 v148, 16, v110
    v_and_b32 v149, 0xffff0000, v110
    v_lshlrev_b32 v150, 16, v114
    v_and_b32 v151, 0xffff0000, v114
    v_mul_f32 v144, v148, v120
    v_mul_f32 v145, v149, v120
    v_fmac_f32 v144, v150, v121
    v_fmac_f32 v145, v151, v121
    v_lshlrev_b32 v148, 16, v111
    v_and_b32 v149, 0xffff0000, v111
    v_lshlrev_b32 v150, 16, v115
    v_and_b32 v151, 0xffff0000, v115
    v_mul_f32 v146, v148, v120
    v_mul_f32 v147, v149, v120
    v_fmac_f32 v146, v150, v121
    v_fmac_f32 v147, v151, v121
    v_lshrrev_b32 v18, 3, v0
    v_lshlrev_b32 v18, 9, v18
    v_and_b32 v19, 7, v0
    v_lshl_add_u32 v18, v19, 5, v18
    v_add_u32 v18, 65536, v18
    ds_write_b128 v18, v[132:135]
    ds_write_b128 v18, v[136:139] offset:16
    ds_write_b128 v18, v[140:143] offset:256
    ds_write_b128 v18, v[144:147] offset:272
    s_waitcnt lgkmcnt(0)
    s_barrier
    s_and_b32 s64, s30, 1
    s_lshr_b32 s65, s30, 1
    v_lshl_add_u32 v9, v4, 3, v5
    v_mul_u32_u24 v9, 192, v9
    v_lshl_add_u32 v10, v7, 2, v6
    v_lshl_add_u32 v9, v10, 3, v9
    s_lshl_b32 s34, s64, 6
    s_add_u32 s34, s34, 32768
    v_add_u32 v11, s34, v9
    s_mul_i32 s34, s64, 80
    s_lshl_b32 s35, s65, 6
    s_add_u32 s34, s34, s35
    s_add_u32 s34, s34, 0
    v_add_u32 v12, s34, v9
    ds_read_b64_tr_b16 v[24:25], v11 offset:0
    ds_read_b64_tr_b16 v[40:41], v12 offset:0
    ds_read_b64_tr_b16 v[26:27], v11 offset:768
    ds_read_b64_tr_b16 v[42:43], v12 offset:768
    ds_read_b64_tr_b16 v[28:29], v11 offset:3072
    ds_read_b64_tr_b16 v[44:45], v12 offset:3072
    ds_read_b64_tr_b16 v[30:31], v11 offset:3840
    ds_read_b64_tr_b16 v[46:47], v12 offset:3840
    ds_read_b64_tr_b16 v[32:33], v11 offset:6144
    ds_read_b64_tr_b16 v[48:49], v12 offset:6144
    ds_read_b64_tr_b16 v[34:35], v11 offset:6912
    ds_read_b64_tr_b16 v[50:51], v12 offset:6912
    ds_read_b64_tr_b16 v[36:37], v11 offset:9216
    ds_read_b64_tr_b16 v[52:53], v12 offset:9216
    ds_read_b64_tr_b16 v[38:39], v11 offset:9984
    ds_read_b64_tr_b16 v[54:55], v12 offset:9984
    ds_read_b64_tr_b16 v[148:149], v11 offset:12288
    ds_read_b64_tr_b16 v[84:85], v12 offset:12288
    ds_read_b64_tr_b16 v[150:151], v11 offset:13056
    ds_read_b64_tr_b16 v[86:87], v12 offset:13056
    ds_read_b64_tr_b16 v[152:153], v11 offset:15360
    ds_read_b64_tr_b16 v[88:89], v12 offset:15360
    ds_read_b64_tr_b16 v[154:155], v11 offset:16128
    ds_read_b64_tr_b16 v[90:91], v12 offset:16128
    ds_read_b64_tr_b16 v[156:157], v11 offset:18432
    ds_read_b64_tr_b16 v[92:93], v12 offset:18432
    ds_read_b64_tr_b16 v[158:159], v11 offset:19200
    ds_read_b64_tr_b16 v[94:95], v12 offset:19200
    ds_read_b64_tr_b16 v[160:161], v11 offset:21504
    ds_read_b64_tr_b16 v[96:97], v12 offset:21504
    ds_read_b64_tr_b16 v[162:163], v11 offset:22272
    ds_read_b64_tr_b16 v[98:99], v12 offset:22272
    s_waitcnt lgkmcnt(15)
    v_mfma_f32_32x32x16_bf16 v[132:147], v[24:27], v[40:43], 0
    s_waitcnt lgkmcnt(15)
    v_mfma_f32_32x32x16_bf16 v[132:147], v[28:31], v[44:47], v[132:147]
    s_waitcnt lgkmcnt(15)
    v_mfma_f32_32x32x16_bf16 v[132:147], v[32:35], v[48:51], v[132:147]
    s_waitcnt lgkmcnt(15)
    v_mfma_f32_32x32x16_bf16 v[132:147], v[36:39], v[52:55], v[132:147]
    s_waitcnt lgkmcnt(12)
    v_mfma_f32_32x32x16_bf16 v[132:147], v[148:151], v[84:87], v[132:147]
    s_waitcnt lgkmcnt(8)
    v_mfma_f32_32x32x16_bf16 v[132:147], v[152:155], v[88:91], v[132:147]
    s_waitcnt lgkmcnt(4)
    v_mfma_f32_32x32x16_bf16 v[132:147], v[156:159], v[92:95], v[132:147]
    s_waitcnt lgkmcnt(0)
    v_mfma_f32_32x32x16_bf16 v[132:147], v[160:163], v[96:99], v[132:147]
    v_and_b32 v18, 127, v0
    v_lshlrev_b32 v19, 2, v18
    v_add_u32 v19, 65536, v19
    s_cmp_ge_u32 s30, 2
    s_cbranch_scc1 K1_NOMOE
    s_cmp_ge_u32 s2, 240
    s_cbranch_scc1 K1_NOMOE
    ds_read_b32 v96, v19 offset:0
    ds_read_b32 v97, v19 offset:512
    ds_read_b32 v98, v19 offset:1024
    ds_read_b32 v99, v19 offset:1536
    ds_read_b32 v100, v19 offset:2048
    ds_read_b32 v101, v19 offset:2560
    ds_read_b32 v102, v19 offset:3072
    ds_read_b32 v103, v19 offset:3584
    ds_read_b32 v104, v19 offset:4096
    ds_read_b32 v105, v19 offset:4608
    ds_read_b32 v106, v19 offset:5120
    ds_read_b32 v107, v19 offset:5632
    ds_read_b32 v108, v19 offset:6144
    ds_read_b32 v109, v19 offset:6656
    ds_read_b32 v110, v19 offset:7168
    ds_read_b32 v111, v19 offset:7680
    ds_read_b32 v112, v19 offset:8192
    ds_read_b32 v113, v19 offset:8704
    ds_read_b32 v114, v19 offset:9216
    ds_read_b32 v115, v19 offset:9728
    ds_read_b32 v116, v19 offset:10240
    ds_read_b32 v117, v19 offset:10752
    ds_read_b32 v118, v19 offset:11264
    ds_read_b32 v119, v19 offset:11776
    ds_read_b32 v120, v19 offset:12288
    ds_read_b32 v121, v19 offset:12800
    ds_read_b32 v122, v19 offset:13312
    ds_read_b32 v123, v19 offset:13824
    ds_read_b32 v124, v19 offset:14336
    ds_read_b32 v125, v19 offset:14848
    ds_read_b32 v126, v19 offset:15360
    ds_read_b32 v127, v19 offset:15872
    s_waitcnt lgkmcnt(15)
    v_add_f32 v96, v96, v97
    v_add_f32 v96, v96, v98
    v_add_f32 v96, v96, v99
    v_add_f32 v96, v96, v100
    v_add_f32 v96, v96, v101
    v_add_f32 v96, v96, v102
    v_add_f32 v96, v96, v103
    v_add_f32 v96, v96, v104
    v_add_f32 v96, v96, v105
    v_add_f32 v96, v96, v106
    v_add_f32 v96, v96, v107
    v_add_f32 v96, v96, v108
    v_add_f32 v96, v96, v109
    v_add_f32 v96, v96, v110
    v_add_f32 v96, v96, v111
    s_waitcnt lgkmcnt(0)
    v_add_f32 v96, v96, v112
    v_add_f32 v96, v96, v113
    v_add_f32 v96, v96, v114
    v_add_f32 v96, v96, v115
    v_add_f32 v96, v96, v116
    v_add_f32 v96, v96, v117
    v_add_f32 v96, v96, v118
    v_add_f32 v96, v96, v119
    v_add_f32 v96, v96, v120
    v_add_f32 v96, v96, v121
    v_add_f32 v96, v96, v122
    v_add_f32 v96, v96, v123
    v_add_f32 v96, v96, v124
    v_add_f32 v96, v96, v125
    v_add_f32 v96, v96, v126
    v_add_f32 v96, v96, v127
    v_lshrrev_b32 v19, 6, v18
    v_mul_u32_u24 v19, 6144, v19
    v_and_b32 v20, 63, v18
    v_lshl_add_u32 v19, v20, 2, v19
    s_mul_i32 s34, s62, 12288
    s_lshl_b32 s35, s63, 8
    s_add_u32 s34, s34, s35
    s_add_u32 s34, s34, 9699328
    buffer_store_dword v96, v19, s[24:27], s34 offen sc0 sc1
K1_NOMOE:
    s_lshl_b32 s34, s28, 5
    s_lshl_b32 s35, s29, 1
    s_add_u32 s34, s34, s35
    s_add_u32 s34, s34, s64
    s_lshl_b32 s34, s34, 1
    s_add_u32 s34, s34, s65
    s_mul_i32 s34, s34, 3072
    s_add_u32 s34, s34, 5242880
    v_lshlrev_b32 v9, 2, v2
    s_cmp_eq_u32 s65, 0
    s_cselect_b32 s35, 32, 8
    v_cmp_gt_u32 vcc, s35, v3
    v_mov_b32 v10, 2130706432
    s_nop 7
    v_cndmask_b32 v9, v10, v9, vcc
    buffer_store_dword v132, v9, s[24:27], s34 offen offset:0 sc0 sc1
    buffer_store_dword v133, v9, s[24:27], s34 offen offset:256 sc0 sc1
    buffer_store_dword v134, v9, s[24:27], s34 offen offset:512 sc0 sc1
    buffer_store_dword v135, v9, s[24:27], s34 offen offset:768 sc0 sc1
    buffer_store_dword v136, v9, s[24:27], s34 offen offset:1024 sc0 sc1
    buffer_store_dword v137, v9, s[24:27], s34 offen offset:1280 sc0 sc1
    buffer_store_dword v138, v9, s[24:27], s34 offen offset:1536 sc0 sc1
    buffer_store_dword v139, v9, s[24:27], s34 offen offset:1792 sc0 sc1
    buffer_store_dword v140, v9, s[24:27], s34 offen offset:2048 sc0 sc1
    buffer_store_dword v141, v9, s[24:27], s34 offen offset:2304 sc0 sc1
    buffer_store_dword v142, v9, s[24:27], s34 offen offset:2560 sc0 sc1
    buffer_store_dword v143, v9, s[24:27], s34 offen offset:2816 sc0 sc1
K1_END:
    s_endpgm
.globl k2_kernel
.p2align 8
.type k2_kernel,@function
k2_kernel:
    s_cmp_ge_u32 s2, 112
    s_cbranch_scc1 K2_END
    s_load_dwordx2 s[12:13], s[0:1], 64
    s_load_dwordx2 s[14:15], s[0:1], 88
    v_lshrrev_b32 v1, 6, v0
    v_and_b32 v2, 63, v0
    s_nop 0
    v_readfirstlane_b32 s92, v1
    s_waitcnt lgkmcnt(0)
    s_mov_b32 s24, s14
    s_and_b32 s25, s15, 0xffff
    s_mov_b32 s26, 20971520
    s_mov_b32 s27, 0x00020000
    s_cmp_ge_u32 s2, 48
    s_cbranch_scc1 K2_MOE
    s_lshl_b32 s31, s2, 2
    s_add_u32 s31, s31, s92
    v_lshlrev_b32 v3, 4, v2
    s_lshl_b32 s32, s31, 10
    s_add_u32 s37, s32, 5242880
    buffer_load_dwordx4 v[16:19], v3, s[24:27], s37 offen
    s_add_u32 s37, s32, 5439488
    buffer_load_dwordx4 v[20:23], v3, s[24:27], s37 offen
    s_add_u32 s37, s32, 5636096
    buffer_load_dwordx4 v[24:27], v3, s[24:27], s37 offen
    s_add_u32 s37, s32, 5832704
    buffer_load_dwordx4 v[28:31], v3, s[24:27], s37 offen
    s_add_u32 s37, s32, 6029312
    buffer_load_dwordx4 v[32:35], v3, s[24:27], s37 offen
    s_add_u32 s37, s32, 6225920
    buffer_load_dwordx4 v[36:39], v3, s[24:27], s37 offen
    s_add_u32 s37, s32, 6422528
    buffer_load_dwordx4 v[40:43], v3, s[24:27], s37 offen
    s_add_u32 s37, s32, 6619136
    buffer_load_dwordx4 v[44:47], v3, s[24:27], s37 offen
    s_add_u32 s37, s32, 6815744
    buffer_load_dwordx4 v[48:51], v3, s[24:27], s37 offen
    s_add_u32 s37, s32, 7012352
    buffer_load_dwordx4 v[52:55], v3, s[24:27], s37 offen
    s_add_u32 s37, s32, 7208960
    buffer_load_dwordx4 v[56:59], v3, s[24:27], s37 offen
    s_add_u32 s37, s32, 7405568
    buffer_load_dwordx4 v[60:63], v3, s[24:27], s37 offen
    s_add_u32 s37, s32, 7602176
    buffer_load_dwordx4 v[64:67], v3, s[24:27], s37 offen
    s_add_u32 s37, s32, 7798784
    buffer_load_dwordx4 v[68:71], v3, s[24:27], s37 offen
    s_add_u32 s37, s32, 7995392
    buffer_load_dwordx4 v[72:75], v3, s[24:27], s37 offen
    s_add_u32 s37, s32, 8192000
    buffer_load_dwordx4 v[76:79], v3, s[24:27], s37 offen
    s_mul_i32 s33, s31, 10923
    s_lshr_b32 s33, s33, 16
    s_mul_i32 s34, s33, 6
    s_sub_u32 s34, s31, s34
    s_cmp_ge_u32 s34, 3
    s_cselect_b32 s35, 1, 0
    s_mul_i32 s36, s35, 3
    s_sub_u32 s36, s34, s36
    s_lshr_b32 s38, s33, 1
    s_and_b32 s39, s33, 1
    v_and_b32 v4, 15, v2
    v_lshrrev_b32 v5, 4, v2
    v_lshrrev_b32 v6, 3, v4
    s_lshl_b32 s40, s36, 3
    v_lshl_add_u32 v7, v6, 2, v5
    v_add_u32 v7, s40, v7
    v_and_b32 v8, 7, v4
    v_lshlrev_b32 v8, 2, v8
    s_lshl_b32 s40, s35, 5
    v_add_u32 v8, s40, v8
    v_lshrrev_b32 v9, 3, v8
    s_mul_i32 s40, s39, 5
    v_add_u32 v9, s40, v9
    v_lshrrev_b32 v10, 1, v9
    v_add_u32 v10, s39, v10
    v_and_b32 v9, 1, v9
    s_mul_i32 s40, s38, 6
    v_add_u32 v10, s40, v10
    v_lshlrev_b32 v10, 6, v10
    v_lshl_add_u32 v10, v9, 5, v10
    v_cmp_le_u32 vcc, 10, v7
    v_subrev_u32 v11, 10, v7
    s_nop 0
    v_cndmask_b32 v11, v7, v11, vcc
    v_cndmask_b32 v12, 0, 4, vcc
    v_lshrrev_b32 v13, 2, v11
    v_lshlrev_b32 v13, 3, v13
    v_and_b32 v14, 3, v11
    v_add3_u32 v13, v13, v14, v12
    v_add_u32 v13, v13, v10
    v_lshlrev_b32 v13, 4, v13
    v_and_b32 v14, 4, v8
    v_lshl_add_u32 v13, v14, 1, v13
    v_cmp_ge_u32 vcc, 20, v7
    v_cmp_gt_u32 s[40:41], 40, v8
    s_and_b64 vcc, vcc, s[40:41]
    v_mov_b32 v14, 2130706432
    v_cmp_eq_u32 s[42:43], 20, v7
    v_cndmask_b32 v13, v14, v13, vcc
    s_and_b64 s[42:43], s[42:43], vcc
    v_subrev_u32 v15, 64, v13
    s_nop 0
    v_cndmask_b32 v15, v14, v15, s[42:43]
    s_waitcnt vmcnt(14)
    v_add_f32 v16, v16, v20
    v_add_f32 v17, v17, v21
    v_add_f32 v18, v18, v22
    v_add_f32 v19, v19, v23
    s_waitcnt vmcnt(13)
    v_add_f32 v16, v16, v24
    v_add_f32 v17, v17, v25
    v_add_f32 v18, v18, v26
    v_add_f32 v19, v19, v27
    s_waitcnt vmcnt(12)
    v_add_f32 v16, v16, v28
    v_add_f32 v17, v17, v29
    v_add_f32 v18, v18, v30
    v_add_f32 v19, v19, v31
    s_waitcnt vmcnt(11)
    v_add_f32 v16, v16, v32
    v_add_f32 v17, v17, v33
    v_add_f32 v18, v18, v34
    v_add_f32 v19, v19, v35
    s_waitcnt vmcnt(10)
    v_add_f32 v16, v16, v36
    v_add_f32 v17, v17, v37
    v_add_f32 v18, v18, v38
    v_add_f32 v19, v19, v39
    s_waitcnt vmcnt(9)
    v_add_f32 v16, v16, v40
    v_add_f32 v17, v17, v41
    v_add_f32 v18, v18, v42
    v_add_f32 v19, v19, v43
    s_waitcnt vmcnt(8)
    v_add_f32 v16, v16, v44
    v_add_f32 v17, v17, v45
    v_add_f32 v18, v18, v46
    v_add_f32 v19, v19, v47
    s_waitcnt vmcnt(7)
    v_add_f32 v16, v16, v48
    v_add_f32 v17, v17, v49
    v_add_f32 v18, v18, v50
    v_add_f32 v19, v19, v51
    s_waitcnt vmcnt(6)
    v_add_f32 v16, v16, v52
    v_add_f32 v17, v17, v53
    v_add_f32 v18, v18, v54
    v_add_f32 v19, v19, v55
    s_waitcnt vmcnt(5)
    v_add_f32 v16, v16, v56
    v_add_f32 v17, v17, v57
    v_add_f32 v18, v18, v58
    v_add_f32 v19, v19, v59
    s_waitcnt vmcnt(4)
    v_add_f32 v16, v16, v60
    v_add_f32 v17, v17, v61
    v_add_f32 v18, v18, v62
    v_add_f32 v19, v19, v63
    s_waitcnt vmcnt(3)
    v_add_f32 v16, v16, v64
    v_add_f32 v17, v17, v65
    v_add_f32 v18, v18, v66
    v_add_f32 v19, v19, v67
    s_waitcnt vmcnt(2)
    v_add_f32 v16, v16, v68
    v_add_f32 v17, v17, v69
    v_add_f32 v18, v18, v70
    v_add_f32 v19, v19, v71
    s_waitcnt vmcnt(1)
    v_add_f32 v16, v16, v72
    v_add_f32 v17, v17, v73
    v_add_f32 v18, v18, v74
    v_add_f32 v19, v19, v75
    s_waitcnt vmcnt(0)
    v_add_f32 v16, v16, v76
    v_add_f32 v17, v17, v77
    v_add_f32 v18, v18, v78
    v_add_f32 v19, v19, v79
    v_cvt_pk_bf16_f32 v20, v16, v17
    v_cvt_pk_bf16_f32 v21, v18, v19
    s_mov_b32 s37, 8454144
    buffer_store_dwordx2 v[20:21], v13, s[24:27], s37 offen sc0 sc1
    buffer_store_dwordx2 v[20:21], v15, s[24:27], s37 offen sc0 sc1
    s_cmp_lg_u32 s34, 3
    s_cbranch_scc1 K2_END2
    s_mul_i32 s40, s38, 6
    s_add_u32 s40, s40, 2
    s_add_u32 s40, s40, s39
    s_lshl_b32 s40, s40, 10
    s_xor_b32 s41, s39, 1
    s_lshl_b32 s41, s41, 9
    s_add_u32 s40, s40, s41
    s_add_u32 s40, s40, 8454144
    v_mov_b32 v24, 0
    v_mov_b32 v25, 0
    v_mov_b32 v26, 0
    v_mov_b32 v27, 0
    v_cmp_gt_u32 vcc, 32, v2
    s_and_saveexec_b64 s[42:43], vcc
    buffer_store_dwordx4 v[24:27], v3, s[24:27], s40 offen sc0 sc1
    s_mov_b64 exec, s[42:43]
    s_branch K2_END2
K2_MOE:
    s_sub_u32 s93, s2, 48
    s_mov_b32 s36, s12
    s_and_b32 s37, s13, 0xffff
    s_mov_b32 s38, 1966080
    s_mov_b32 s39, 0x00020000
    v_mul_u32_u24 v6, 205, v0
    v_lshrrev_b32 v6, 14, v6
    v_mul_u32_u24 v7, 80, v6
    v_sub_u32 v7, v0, v7
    s_mul_i32 s44, s93, 24
    v_add_u32 v8, s44, v6
    v_mul_u32_u24 v8, 1280, v8
    v_lshl_add_u32 v8, v7, 4, v8
    v_cmp_gt_u32 vcc, 3, v6
    v_mov_b32 v9, 2130706432
    s_nop 0
    v_cndmask_b32 v8, v9, v8, vcc
    v_mul_u32_u24 v10, 2731, v0
    v_lshrrev_b32 v10, 16, v10
    v_mul_u32_u24 v11, 24, v10
    v_sub_u32 v11, v0, v11
    v_mul_u32_u24 v10, 6144, v10
    v_lshl_add_u32 v10, v11, 2, v10
    s_mul_i32 s44, s93, 96
    v_add_u32 v10, s44, v10
    v_cmp_gt_u32 vcc, 48, v0
    s_nop 1
    v_cndmask_b32 v10, v9, v10, vcc
    s_mov_b32 s45, 9699328
    buffer_load_dword v12, v10, s[24:27], s45 offen
    s_mov_b32 s45, 9711616
    buffer_load_dword v13, v10, s[24:27], s45 offen
    s_mov_b32 s45, 9723904
    buffer_load_dword v14, v10, s[24:27], s45 offen
    s_mov_b32 s45, 9736192
    buffer_load_dword v15, v10, s[24:27], s45 offen
    s_mov_b32 s45, 9748480
    buffer_load_dword v16, v10, s[24:27], s45 offen
    s_mov_b32 s45, 9760768
    buffer_load_dword v17, v10, s[24:27], s45 offen
    s_mov_b32 s45, 9773056
    buffer_load_dword v18, v10, s[24:27], s45 offen
    s_mov_b32 s45, 9785344
    buffer_load_dword v19, v10, s[24:27], s45 offen
    s_mov_b32 s45, 9797632
    buffer_load_dword v20, v10, s[24:27], s45 offen
    s_mov_b32 s45, 9809920
    buffer_load_dword v21, v10, s[24:27], s45 offen
    s_mov_b32 s45, 0
    buffer_load_dwordx4 v[32:35], v8, s[36:39], s45 offen
    s_mov_b32 s45, 3840
    buffer_load_dwordx4 v[36:39], v8, s[36:39], s45 offen
    s_mov_b32 s45, 7680
    buffer_load_dwordx4 v[40:43], v8, s[36:39], s45 offen
    s_mov_b32 s45, 11520
    buffer_load_dwordx4 v[44:47], v8, s[36:39], s45 offen
    s_mov_b32 s45, 15360
    buffer_load_dwordx4 v[48:51], v8, s[36:39], s45 offen
    s_mov_b32 s45, 19200
    buffer_load_dwordx4 v[52:55], v8, s[36:39], s45 offen
    s_mov_b32 s45, 23040
    buffer_load_dwordx4 v[56:59], v8, s[36:39], s45 offen
    s_mov_b32 s45, 26880
    buffer_load_dwordx4 v[60:63], v8, s[36:39], s45 offen
    s_waitcnt vmcnt(8)
    v_add_f32 v12, v12, v13
    v_add_f32 v12, v12, v14
    v_add_f32 v12, v12, v15
    v_add_f32 v12, v12, v16
    v_add_f32 v12, v12, v17
    v_add_f32 v12, v12, v18
    v_add_f32 v12, v12, v19
    v_add_f32 v12, v12, v20
    v_add_f32 v12, v12, v21
    v_cvt_pk_bf16_f32 v12, v12, v12
    v_lshlrev_b32 v12, 16, v12
    v_lshlrev_b32 v11, 2, v0
    v_cmp_gt_u32 vcc, 64, v0
    s_and_saveexec_b64 s[56:57], vcc
    ds_write_b32 v11, v12
    s_waitcnt lgkmcnt(0)
    ds_read_b32 v13, v11 offset:96
    s_waitcnt lgkmcnt(0)
    s_mov_b32 s60, 0x3fb8aa3b
    v_mul_f32 v17, s60, v12
    v_exp_f32 v17, -v17
    s_nop 0
    v_add_f32 v17, 1.0, v17
    v_rcp_f32 v17, v17
    s_nop 0
    v_mul_f32 v16, v12, v17
    v_cvt_pk_bf16_f32 v16, v16, v16
    v_lshlrev_b32 v16, 16, v16
    v_mul_f32 v16, v16, v13
    v_cvt_pk_bf16_f32 v16, v16, v16
    v_lshlrev_b32 v16, 16, v16
    ds_write_b32 v11, v16 offset:512
    s_mov_b64 exec, s[56:57]
    s_waitcnt lgkmcnt(0)
    s_barrier
    v_lshlrev_b32 v11, 2, v6
    ds_read_b32 v12, v11 offset:512
    ds_read_b32 v13, v11 offset:524
    ds_read_b32 v14, v11 offset:536
    ds_read_b32 v15, v11 offset:548
    ds_read_b32 v16, v11 offset:560
    ds_read_b32 v17, v11 offset:572
    ds_read_b32 v18, v11 offset:584
    ds_read_b32 v19, v11 offset:596
    s_waitcnt vmcnt(0) lgkmcnt(0)
    v_cmp_gt_u32 vcc, 3, v6
    s_nop 1
    v_cndmask_b32 v12, 0, v12, vcc
    v_cndmask_b32 v13, 0, v13, vcc
    v_cndmask_b32 v14, 0, v14, vcc
    v_cndmask_b32 v15, 0, v15, vcc
    v_cndmask_b32 v16, 0, v16, vcc
    v_cndmask_b32 v17, 0, v17, vcc
    v_cndmask_b32 v18, 0, v18, vcc
    v_cndmask_b32 v19, 0, v19, vcc
    v_lshlrev_b32 v24, 16, v32
    v_and_b32 v25, 0xffff0000, v32
    v_mul_f32 v72, v24, v12
    v_mul_f32 v73, v25, v12
    v_lshlrev_b32 v24, 16, v33
    v_and_b32 v25, 0xffff0000, v33
    v_mul_f32 v74, v24, v12
    v_mul_f32 v75, v25, v12
    v_lshlrev_b32 v24, 16, v34
    v_and_b32 v25, 0xffff0000, v34
    v_mul_f32 v76, v24, v12
    v_mul_f32 v77, v25, v12
    v_lshlrev_b32 v24, 16, v35
    v_and_b32 v25, 0xffff0000, v35
    v_mul_f32 v78, v24, v12
    v_mul_f32 v79, v25, v12
    v_lshlrev_b32 v24, 16, v36
    v_and_b32 v25, 0xffff0000, v36
    v_fmac_f32 v72, v24, v13
    v_fmac_f32 v73, v25, v13
    v_lshlrev_b32 v24, 16, v37
    v_and_b32 v25, 0xffff0000, v37
    v_fmac_f32 v74, v24, v13
    v_fmac_f32 v75, v25, v13
    v_lshlrev_b32 v24, 16, v38
    v_and_b32 v25, 0xffff0000, v38
    v_fmac_f32 v76, v24, v13
    v_fmac_f32 v77, v25, v13
    v_lshlrev_b32 v24, 16, v39
    v_and_b32 v25, 0xffff0000, v39
    v_fmac_f32 v78, v24, v13
    v_fmac_f32 v79, v25, v13
    v_lshlrev_b32 v24, 16, v40
    v_and_b32 v25, 0xffff0000, v40
    v_fmac_f32 v72, v24, v14
    v_fmac_f32 v73, v25, v14
    v_lshlrev_b32 v24, 16, v41
    v_and_b32 v25, 0xffff0000, v41
    v_fmac_f32 v74, v24, v14
    v_fmac_f32 v75, v25, v14
    v_lshlrev_b32 v24, 16, v42
    v_and_b32 v25, 0xffff0000, v42
    v_fmac_f32 v76, v24, v14
    v_fmac_f32 v77, v25, v14
    v_lshlrev_b32 v24, 16, v43
    v_and_b32 v25, 0xffff0000, v43
    v_fmac_f32 v78, v24, v14
    v_fmac_f32 v79, v25, v14
    v_lshlrev_b32 v24, 16, v44
    v_and_b32 v25, 0xffff0000, v44
    v_fmac_f32 v72, v24, v15
    v_fmac_f32 v73, v25, v15
    v_lshlrev_b32 v24, 16, v45
    v_and_b32 v25, 0xffff0000, v45
    v_fmac_f32 v74, v24, v15
    v_fmac_f32 v75, v25, v15
    v_lshlrev_b32 v24, 16, v46
    v_and_b32 v25, 0xffff0000, v46
    v_fmac_f32 v76, v24, v15
    v_fmac_f32 v77, v25, v15
    v_lshlrev_b32 v24, 16, v47
    v_and_b32 v25, 0xffff0000, v47
    v_fmac_f32 v78, v24, v15
    v_fmac_f32 v79, v25, v15
    v_lshlrev_b32 v24, 16, v48
    v_and_b32 v25, 0xffff0000, v48
    v_fmac_f32 v72, v24, v16
    v_fmac_f32 v73, v25, v16
    v_lshlrev_b32 v24, 16, v49
    v_and_b32 v25, 0xffff0000, v49
    v_fmac_f32 v74, v24, v16
    v_fmac_f32 v75, v25, v16
    v_lshlrev_b32 v24, 16, v50
    v_and_b32 v25, 0xffff0000, v50
    v_fmac_f32 v76, v24, v16
    v_fmac_f32 v77, v25, v16
    v_lshlrev_b32 v24, 16, v51
    v_and_b32 v25, 0xffff0000, v51
    v_fmac_f32 v78, v24, v16
    v_fmac_f32 v79, v25, v16
    v_lshlrev_b32 v24, 16, v52
    v_and_b32 v25, 0xffff0000, v52
    v_fmac_f32 v72, v24, v17
    v_fmac_f32 v73, v25, v17
    v_lshlrev_b32 v24, 16, v53
    v_and_b32 v25, 0xffff0000, v53
    v_fmac_f32 v74, v24, v17
    v_fmac_f32 v75, v25, v17
    v_lshlrev_b32 v24, 16, v54
    v_and_b32 v25, 0xffff0000, v54
    v_fmac_f32 v76, v24, v17
    v_fmac_f32 v77, v25, v17
    v_lshlrev_b32 v24, 16, v55
    v_and_b32 v25, 0xffff0000, v55
    v_fmac_f32 v78, v24, v17
    v_fmac_f32 v79, v25, v17
    v_lshlrev_b32 v24, 16, v56
    v_and_b32 v25, 0xffff0000, v56
    v_fmac_f32 v72, v24, v18
    v_fmac_f32 v73, v25, v18
    v_lshlrev_b32 v24, 16, v57
    v_and_b32 v25, 0xffff0000, v57
    v_fmac_f32 v74, v24, v18
    v_fmac_f32 v75, v25, v18
    v_lshlrev_b32 v24, 16, v58
    v_and_b32 v25, 0xffff0000, v58
    v_fmac_f32 v76, v24, v18
    v_fmac_f32 v77, v25, v18
    v_lshlrev_b32 v24, 16, v59
    v_and_b32 v25, 0xffff0000, v59
    v_fmac_f32 v78, v24, v18
    v_fmac_f32 v79, v25, v18
    v_lshlrev_b32 v24, 16, v60
    v_and_b32 v25, 0xffff0000, v60
    v_fmac_f32 v72, v24, v19
    v_fmac_f32 v73, v25, v19
    v_lshlrev_b32 v24, 16, v61
    v_and_b32 v25, 0xffff0000, v61
    v_fmac_f32 v74, v24, v19
    v_fmac_f32 v75, v25, v19
    v_lshlrev_b32 v24, 16, v62
    v_and_b32 v25, 0xffff0000, v62
    v_fmac_f32 v76, v24, v19
    v_fmac_f32 v77, v25, v19
    v_lshlrev_b32 v24, 16, v63
    v_and_b32 v25, 0xffff0000, v63
    v_fmac_f32 v78, v24, v19
    v_fmac_f32 v79, v25, v19
    v_lshlrev_b32 v11, 5, v0
    ds_write_b128 v11, v[72:75] offset:4096
    ds_write_b128 v11, v[76:79] offset:4112
    s_waitcnt lgkmcnt(0)
    s_barrier
    v_cmp_gt_u32 vcc, 160, v0
    s_and_saveexec_b64 s[56:57], vcc
    v_lshlrev_b32 v11, 4, v0
    ds_read_b128 v[16:19], v11 offset:4096
    ds_read_b128 v[20:23], v11 offset:6656
    ds_read_b128 v[24:27], v11 offset:9216
    s_waitcnt lgkmcnt(0)
    v_add_f32 v16, v16, v20
    v_add_f32 v16, v16, v24
    v_add_f32 v17, v17, v21
    v_add_f32 v17, v17, v25
    v_add_f32 v18, v18, v22
    v_add_f32 v18, v18, v26
    v_add_f32 v19, v19, v23
    v_add_f32 v19, v19, v27
    s_mul_i32 s44, s93, 2560
    s_add_u32 s44, s44, 9437184
    buffer_store_dwordx4 v[16:19], v11, s[24:27], s44 offen sc0 sc1
    s_mov_b64 exec, -1
K2_END2:
K2_END:
    s_endpgm
.globl k3_kernel
.p2align 8
.type k3_kernel,@function
k3_kernel:
    s_cmp_ge_u32 s2, 256
    s_cbranch_scc1 K3_END
    s_load_dwordx2 s[4:5], s[0:1], 0
    s_load_dwordx2 s[6:7], s[0:1], 72
    s_load_dwordx2 s[14:15], s[0:1], 88
    v_lshrrev_b32 v1, 6, v0
    v_and_b32 v2, 63, v0
    v_lshlrev_b32 v3, 4, v2
    v_readfirstlane_b32 s30, v1
    s_and_b32 s31, s2, 7
    s_lshr_b32 s32, s2, 3
    s_and_b32 s33, s32, 3
    s_lshr_b32 s32, s32, 2
    s_lshl_b32 s31, s31, 3
    s_add_u32 s34, s31, s32
    s_waitcnt lgkmcnt(0)
    s_add_u32 s80, s14, 8409088
    s_addc_u32 s81, s15, 0
    s_load_dword s46, s[80:81], 0
    s_mov_b32 s24, s14
    s_and_b32 s25, s15, 0xffff
    s_mov_b32 s26, 20971520
    s_mov_b32 s27, 0x00020000
    s_mov_b32 s16, s4
    s_and_b32 s17, s5, 0xffff
    s_mov_b32 s18, 2621440
    s_mov_b32 s19, 0x00020000
    s_mov_b32 s20, s6
    s_and_b32 s21, s7, 0xffff
    s_mov_b32 s22, 2621440
    s_mov_b32 s23, 0x00020000
    s_lshl_b32 s35, s34, 5
    s_mul_i32 s36, s33, 320
    s_lshl_b32 s37, s34, 4
    s_lshl_b32 s38, s30, 2
    s_add_u32 s37, s37, s38
    s_mul_i32 s37, s37, 5120
    s_mul_i32 s38, s30, 24576
    s_add_u32 s38, s38, 8454144
    s_mul_i32 s39, s30, 200
    s_mul_i32 s40, s33, 50
    s_add_u32 s39, s39, s40
    s_lshl_b32 s39, s39, 10
    s_add_u32 s39, s39, 8585216
    v_and_b32 v4, 31, v2
    v_cmp_gt_u32 vcc, 24, v4
    v_mov_b32 v5, 2130706432
    s_nop 0
    v_cndmask_b32 v7, v5, v3, vcc
    s_add_u32 s41, s37, 0
    buffer_load_dwordx4 a[0:3], v3, s[24:27], s41 offen offset:0
    s_add_u32 s41, s37, 0
    buffer_load_dwordx4 a[4:7], v3, s[24:27], s41 offen offset:1024
    s_add_u32 s41, s37, 0
    buffer_load_dwordx4 a[8:11], v3, s[24:27], s41 offen offset:2048
    s_add_u32 s41, s37, 0
    buffer_load_dwordx4 a[12:15], v3, s[24:27], s41 offen offset:3072
    s_add_u32 s41, s37, 4096
    buffer_load_dwordx4 a[16:19], v3, s[24:27], s41 offen offset:0
    s_add_u32 s41, s38, 0
    buffer_load_dwordx4 a[80:83], v7, s[24:27], s41 offen offset:0
    s_add_u32 s41, s38, 0
    buffer_load_dwordx4 a[84:87], v7, s[24:27], s41 offen offset:1024
    s_add_u32 s41, s38, 0
    buffer_load_dwordx4 a[88:91], v7, s[24:27], s41 offen offset:2048
    s_add_u32 s41, s38, 0
    buffer_load_dwordx4 a[92:95], v7, s[24:27], s41 offen offset:3072
    s_add_u32 s41, s38, 4096
    buffer_load_dwordx4 a[96:99], v7, s[24:27], s41 offen offset:0
    s_add_u32 s41, s38, 4096
    buffer_load_dwordx4 a[100:103], v7, s[24:27], s41 offen offset:1024
    s_add_u32 s41, s37, 4096
    buffer_load_dwordx4 a[20:23], v3, s[24:27], s41 offen offset:1024
    s_add_u32 s41, s37, 4096
    buffer_load_dwordx4 a[24:27], v3, s[24:27], s41 offen offset:2048
    s_add_u32 s41, s37, 4096
    buffer_load_dwordx4 a[28:31], v3, s[24:27], s41 offen offset:3072
    s_add_u32 s41, s37, 8192
    buffer_load_dwordx4 a[32:35], v3, s[24:27], s41 offen offset:0
    s_add_u32 s41, s37, 8192
    buffer_load_dwordx4 a[36:39], v3, s[24:27], s41 offen offset:1024
    s_add_u32 s41, s38, 4096
    buffer_load_dwordx4 a[104:107], v7, s[24:27], s41 offen offset:2048
    s_add_u32 s41, s38, 4096
    buffer_load_dwordx4 a[108:111], v7, s[24:27], s41 offen offset:3072
    s_add_u32 s41, s38, 8192
    buffer_load_dwordx4 a[112:115], v7, s[24:27], s41 offen offset:0
    s_add_u32 s41, s38, 8192
    buffer_load_dwordx4 a[116:119], v7, s[24:27], s41 offen offset:1024
    s_add_u32 s41, s38, 8192
    buffer_load_dwordx4 a[120:123], v7, s[24:27], s41 offen offset:2048
    s_add_u32 s41, s38, 8192
    buffer_load_dwordx4 a[124:127], v7, s[24:27], s41 offen offset:3072
    s_add_u32 s41, s37, 8192
    buffer_load_dwordx4 a[40:43], v3, s[24:27], s41 offen offset:2048
    s_add_u32 s41, s37, 8192
    buffer_load_dwordx4 a[44:47], v3, s[24:27], s41 offen offset:3072
    s_add_u32 s41, s37, 12288
    buffer_load_dwordx4 a[48:51], v3, s[24:27], s41 offen offset:0
    s_add_u32 s41, s37, 12288
    buffer_load_dwordx4 a[52:55], v3, s[24:27], s41 offen offset:1024
    s_add_u32 s41, s37, 12288
    buffer_load_dwordx4 a[56:59], v3, s[24:27], s41 offen offset:2048
    s_add_u32 s41, s38, 12288
    buffer_load_dwordx4 a[128:131], v7, s[24:27], s41 offen offset:0
    s_add_u32 s41, s38, 12288
    buffer_load_dwordx4 a[132:135], v7, s[24:27], s41 offen offset:1024
    s_add_u32 s41, s38, 12288
    buffer_load_dwordx4 a[136:139], v7, s[24:27], s41 offen offset:2048
    s_add_u32 s41, s38, 12288
    buffer_load_dwordx4 a[140:143], v7, s[24:27], s41 offen offset:3072
    s_add_u32 s41, s38, 16384
    buffer_load_dwordx4 a[144:147], v7, s[24:27], s41 offen offset:0
    s_add_u32 s41, s38, 16384
    buffer_load_dwordx4 a[148:151], v7, s[24:27], s41 offen offset:1024
    s_add_u32 s41, s37, 12288
    buffer_load_dwordx4 a[60:63], v3, s[24:27], s41 offen offset:3072
    s_add_u32 s41, s37, 16384
    buffer_load_dwordx4 a[64:67], v3, s[24:27], s41 offen offset:0
    s_add_u32 s41, s37, 16384
    buffer_load_dwordx4 a[68:71], v3, s[24:27], s41 offen offset:1024
    s_add_u32 s41, s37, 16384
    buffer_load_dwordx4 a[72:75], v3, s[24:27], s41 offen offset:2048
    s_add_u32 s41, s37, 16384
    buffer_load_dwordx4 a[76:79], v3, s[24:27], s41 offen offset:3072
    s_add_u32 s41, s38, 16384
    buffer_load_dwordx4 a[152:155], v7, s[24:27], s41 offen offset:2048
    s_add_u32 s41, s38, 16384
    buffer_load_dwordx4 a[156:159], v7, s[24:27], s41 offen offset:3072
    s_add_u32 s41, s38, 20480
    buffer_load_dwordx4 a[160:163], v7, s[24:27], s41 offen offset:0
    s_add_u32 s41, s38, 20480
    buffer_load_dwordx4 a[164:167], v7, s[24:27], s41 offen offset:1024
    s_add_u32 s41, s38, 20480
    buffer_load_dwordx4 a[168:171], v7, s[24:27], s41 offen offset:2048
    s_add_u32 s41, s38, 20480
    buffer_load_dwordx4 a[172:175], v7, s[24:27], s41 offen offset:3072
    s_mov_b32 s42, 8388608
    v_add_u32 v4, 0, v0
    v_mul_u32_u24 v8, 1639, v4
    v_lshrrev_b32 v8, 16, v8
    v_mul_u32_u24 v5, 40, v8
    v_sub_u32 v13, v4, v5
    v_add_u32 v8, s35, v8
    v_mul_u32_u24 v6, 1280, v8
    v_lshl_add_u32 v6, v13, 3, v6
    v_add_u32 v18, s36, v6
    buffer_load_dwordx2 v[24:25], v18, s[16:19], 0 offen
    v_lshlrev_b32 v5, 3, v8
    buffer_load_dwordx2 v[34:35], v5, s[24:27], s42 offen
    v_add_u32 v4, 256, v0
    v_mul_u32_u24 v9, 1639, v4
    v_lshrrev_b32 v9, 16, v9
    v_mul_u32_u24 v5, 40, v9
    v_sub_u32 v14, v4, v5
    v_add_u32 v9, s35, v9
    v_mul_u32_u24 v6, 1280, v9
    v_lshl_add_u32 v6, v14, 3, v6
    v_add_u32 v19, s36, v6
    buffer_load_dwordx2 v[26:27], v19, s[16:19], 0 offen
    v_lshlrev_b32 v5, 3, v9
    buffer_load_dwordx2 v[36:37], v5, s[24:27], s42 offen
    v_add_u32 v4, 512, v0
    v_mul_u32_u24 v10, 1639, v4
    v_lshrrev_b32 v10, 16, v10
    v_mul_u32_u24 v5, 40, v10
    v_sub_u32 v15, v4, v5
    v_add_u32 v10, s35, v10
    v_mul_u32_u24 v6, 1280, v10
    v_lshl_add_u32 v6, v15, 3, v6
    v_add_u32 v20, s36, v6
    buffer_load_dwordx2 v[28:29], v20, s[16:19], 0 offen
    v_lshlrev_b32 v5, 3, v10
    buffer_load_dwordx2 v[38:39], v5, s[24:27], s42 offen
    v_add_u32 v4, 768, v0
    v_mul_u32_u24 v11, 1639, v4
    v_lshrrev_b32 v11, 16, v11
    v_mul_u32_u24 v5, 40, v11
    v_sub_u32 v16, v4, v5
    v_add_u32 v11, s35, v11
    v_mul_u32_u24 v6, 1280, v11
    v_lshl_add_u32 v6, v16, 3, v6
    v_add_u32 v21, s36, v6
    buffer_load_dwordx2 v[30:31], v21, s[16:19], 0 offen
    v_lshlrev_b32 v5, 3, v11
    buffer_load_dwordx2 v[40:41], v5, s[24:27], s42 offen
    v_add_u32 v4, 1024, v0
    v_mul_u32_u24 v12, 1639, v4
    v_lshrrev_b32 v12, 16, v12
    v_mul_u32_u24 v5, 40, v12
    v_sub_u32 v17, v4, v5
    v_add_u32 v12, s35, v12
    v_mul_u32_u24 v6, 1280, v12
    v_lshl_add_u32 v6, v17, 3, v6
    v_add_u32 v22, s36, v6
    buffer_load_dwordx2 v[32:33], v22, s[16:19], 0 offen
    v_lshlrev_b32 v5, 3, v12
    buffer_load_dwordx2 v[42:43], v5, s[24:27], s42 offen
    s_waitcnt lgkmcnt(0)
    s_and_b32 s47, s46, 0xffff
    s_sub_u32 s47, 0xffff, s47
    s_lshr_b32 s48, s46, 16
    s_and_b32 s90, s48, 0x8000
    s_cmp_eq_u32 s90, 0
    s_mov_b32 s91, 0x8000
    s_cselect_b32 s90, 0xffff, s91
    s_xor_b32 s48, s48, s90
    s_lshl_b32 s48, s48, 16
    s_lshr_b32 s49, s47, 5
    s_cmp_lg_u32 s49, s34
    s_cbranch_scc1 K3_NOYL
    v_mul_u32_u24 v4, 1639, v0
    v_lshrrev_b32 v4, 16, v4
    v_mul_u32_u24 v5, 40, v4
    v_sub_u32 v5, v0, v5
    v_mul_u32_u24 v6, 2560, v4
    v_lshl_add_u32 v6, v5, 4, v6
    s_mul_i32 s50, s33, 640
    v_add_u32 v6, s50, v6
    v_mov_b32 v23, 2130706432
    v_cmp_gt_u32 vcc, 6, v4
    s_nop 1
    v_cndmask_b32 v6, v23, v6, vcc
    v_cmp_gt_u32 vcc, 4, v4
    s_nop 1
    v_cndmask_b32 v23, v23, v6, vcc
    s_mov_b32 s50, 9437184
    buffer_load_dwordx4 v[192:195], v6, s[24:27], s50 offen
    s_mov_b32 s50, 9452544
    buffer_load_dwordx4 v[196:199], v6, s[24:27], s50 offen
    s_mov_b32 s50, 9467904
    buffer_load_dwordx4 v[200:203], v6, s[24:27], s50 offen
    s_mov_b32 s50, 9483264
    buffer_load_dwordx4 v[204:207], v6, s[24:27], s50 offen
    s_mov_b32 s50, 9498624
    buffer_load_dwordx4 v[208:211], v6, s[24:27], s50 offen
    s_mov_b32 s50, 9513984
    buffer_load_dwordx4 v[212:215], v6, s[24:27], s50 offen
    s_mov_b32 s50, 9529344
    buffer_load_dwordx4 v[216:219], v6, s[24:27], s50 offen
    s_mov_b32 s50, 9544704
    buffer_load_dwordx4 v[220:223], v6, s[24:27], s50 offen
    s_mov_b32 s50, 9560064
    buffer_load_dwordx4 v[224:227], v6, s[24:27], s50 offen
    s_mov_b32 s50, 9575424
    buffer_load_dwordx4 v[228:231], v6, s[24:27], s50 offen
    s_mov_b32 s50, 9590784
    buffer_load_dwordx4 v[232:235], v23, s[24:27], s50 offen
K3_NOYL:
    s_waitcnt vmcnt(43)
    v_mfma_f32_32x32x16_bf16 v[44:59], a[80:83], a[0:3], 0
    v_mfma_f32_32x32x16_bf16 v[44:59], a[84:87], a[4:7], v[44:59]
    v_mfma_f32_32x32x16_bf16 v[44:59], a[88:91], a[8:11], v[44:59]
    v_mfma_f32_32x32x16_bf16 v[60:75], a[92:95], a[8:11], 0
    v_mfma_f32_32x32x16_bf16 v[60:75], a[96:99], a[12:15], v[60:75]
    v_mfma_f32_32x32x16_bf16 v[60:75], a[100:103], a[16:19], v[60:75]
    s_add_u32 s41, s39, 0
    buffer_load_dwordx4 a[176:179], v3, s[24:27], s41 offen offset:0
    s_add_u32 s41, s39, 8192
    buffer_load_dwordx4 a[180:183], v3, s[24:27], s41 offen offset:2048
    s_add_u32 s41, s39, 20480
    buffer_load_dwordx4 a[184:187], v3, s[24:27], s41 offen offset:0
    s_add_u32 s41, s39, 28672
    buffer_load_dwordx4 a[188:191], v3, s[24:27], s41 offen offset:2048
    s_add_u32 s41, s39, 40960
    buffer_load_dwordx4 a[192:195], v3, s[24:27], s41 offen offset:0
    s_waitcnt vmcnt(37)
    v_mfma_f32_32x32x16_bf16 v[76:91], a[104:107], a[20:23], 0
    v_mfma_f32_32x32x16_bf16 v[76:91], a[108:111], a[24:27], v[76:91]
    v_mfma_f32_32x32x16_bf16 v[76:91], a[112:115], a[28:31], v[76:91]
    v_mfma_f32_32x32x16_bf16 v[92:107], a[116:119], a[28:31], 0
    v_mfma_f32_32x32x16_bf16 v[92:107], a[120:123], a[32:35], v[92:107]
    v_mfma_f32_32x32x16_bf16 v[92:107], a[124:127], a[36:39], v[92:107]
    v_add_f32 v240, 0x358637bd, v54
    v_rcp_f32 v240, v240
    s_nop 0
    v_mul_f32 v44, v44, v240
    v_mul_f32 v45, v45, v240
    v_mul_f32 v46, v46, v240
    v_mul_f32 v47, v47, v240
    v_mul_f32 v48, v48, v240
    v_mul_f32 v49, v49, v240
    v_mul_f32 v50, v50, v240
    v_mul_f32 v51, v51, v240
    v_mul_f32 v52, v52, v240
    v_mul_f32 v53, v53, v240
    v_cvt_pk_bf16_f32 v108, v44, v45
    v_cvt_pk_bf16_f32 v109, v46, v47
    v_cvt_pk_bf16_f32 v110, v48, v49
    v_cvt_pk_bf16_f32 v111, v50, v51
    v_cvt_pk_bf16_f32 v112, v52, v53
    v_add_f32 v240, 0x358637bd, v70
    v_rcp_f32 v240, v240
    s_nop 0
    v_mul_f32 v60, v60, v240
    v_mul_f32 v61, v61, v240
    v_mul_f32 v62, v62, v240
    v_mul_f32 v63, v63, v240
    v_mul_f32 v64, v64, v240
    v_mul_f32 v65, v65, v240
    v_mul_f32 v66, v66, v240
    v_mul_f32 v67, v67, v240
    v_mul_f32 v68, v68, v240
    v_mul_f32 v69, v69, v240
    v_cvt_pk_bf16_f32 v113, v60, v61
    v_cvt_pk_bf16_f32 v114, v62, v63
    v_cvt_pk_bf16_f32 v115, v64, v65
    v_cvt_pk_bf16_f32 v116, v66, v67
    v_cvt_pk_bf16_f32 v117, v68, v69
    s_add_u32 s41, s39, 0
    buffer_load_dwordx4 a[196:199], v3, s[24:27], s41 offen offset:1024
    s_add_u32 s41, s39, 8192
    buffer_load_dwordx4 a[200:203], v3, s[24:27], s41 offen offset:3072
    s_add_u32 s41, s39, 20480
    buffer_load_dwordx4 a[204:207], v3, s[24:27], s41 offen offset:1024
    s_add_u32 s41, s39, 28672
    buffer_load_dwordx4 a[208:211], v3, s[24:27], s41 offen offset:3072
    s_add_u32 s41, s39, 40960
    buffer_load_dwordx4 a[212:215], v3, s[24:27], s41 offen offset:1024
    s_waitcnt vmcnt(31)
    v_mfma_f32_32x32x16_bf16 v[44:59], a[128:131], a[40:43], 0
    v_mfma_f32_32x32x16_bf16 v[44:59], a[132:135], a[44:47], v[44:59]
    v_mfma_f32_32x32x16_bf16 v[44:59], a[136:139], a[48:51], v[44:59]
    v_mfma_f32_32x32x16_bf16 v[60:75], a[140:143], a[48:51], 0
    v_mfma_f32_32x32x16_bf16 v[60:75], a[144:147], a[52:55], v[60:75]
    v_mfma_f32_32x32x16_bf16 v[60:75], a[148:151], a[56:59], v[60:75]
    v_add_f32 v240, 0x358637bd, v86
    v_rcp_f32 v240, v240
    s_nop 0
    v_mul_f32 v76, v76, v240
    v_mul_f32 v77, v77, v240
    v_mul_f32 v78, v78, v240
    v_mul_f32 v79, v79, v240
    v_mul_f32 v80, v80, v240
    v_mul_f32 v81, v81, v240
    v_mul_f32 v82, v82, v240
    v_mul_f32 v83, v83, v240
    v_mul_f32 v84, v84, v240
    v_mul_f32 v85, v85, v240
    v_cvt_pk_bf16_f32 v118, v76, v77
    v_cvt_pk_bf16_f32 v119, v78, v79
    v_cvt_pk_bf16_f32 v120, v80, v81
    v_cvt_pk_bf16_f32 v121, v82, v83
    v_cvt_pk_bf16_f32 v122, v84, v85
    v_add_f32 v240, 0x358637bd, v102
    v_rcp_f32 v240, v240
    s_nop 0
    v_mul_f32 v92, v92, v240
    v_mul_f32 v93, v93, v240
    v_mul_f32 v94, v94, v240
    v_mul_f32 v95, v95, v240
    v_mul_f32 v96, v96, v240
    v_mul_f32 v97, v97, v240
    v_mul_f32 v98, v98, v240
    v_mul_f32 v99, v99, v240
    v_mul_f32 v100, v100, v240
    v_mul_f32 v101, v101, v240
    v_cvt_pk_bf16_f32 v123, v92, v93
    v_cvt_pk_bf16_f32 v124, v94, v95
    v_cvt_pk_bf16_f32 v125, v96, v97
    v_cvt_pk_bf16_f32 v126, v98, v99
    v_cvt_pk_bf16_f32 v127, v100, v101
    s_add_u32 s41, s39, 0
    buffer_load_dwordx4 a[216:219], v3, s[24:27], s41 offen offset:2048
    s_add_u32 s41, s39, 12288
    buffer_load_dwordx4 a[220:223], v3, s[24:27], s41 offen offset:0
    s_add_u32 s41, s39, 20480
    buffer_load_dwordx4 a[224:227], v3, s[24:27], s41 offen offset:2048
    s_add_u32 s41, s39, 32768
    buffer_load_dwordx4 a[228:231], v3, s[24:27], s41 offen offset:0
    s_add_u32 s41, s39, 40960
    buffer_load_dwordx4 a[232:235], v3, s[24:27], s41 offen offset:2048
    s_add_u32 s41, s39, 0
    buffer_load_dwordx4 a[236:239], v3, s[24:27], s41 offen offset:3072
    s_add_u32 s41, s39, 12288
    buffer_load_dwordx4 a[240:243], v3, s[24:27], s41 offen offset:1024
    s_add_u32 s41, s39, 20480
    buffer_load_dwordx4 a[244:247], v3, s[24:27], s41 offen offset:3072
    s_add_u32 s41, s39, 32768
    buffer_load_dwordx4 a[248:251], v3, s[24:27], s41 offen offset:1024
    s_add_u32 s41, s39, 40960
    buffer_load_dwordx4 a[252:255], v3, s[24:27], s41 offen offset:3072
    s_waitcnt vmcnt(30)
    v_mfma_f32_32x32x16_bf16 v[76:91], a[152:155], a[60:63], 0
    v_mfma_f32_32x32x16_bf16 v[76:91], a[156:159], a[64:67], v[76:91]
    v_mfma_f32_32x32x16_bf16 v[76:91], a[160:163], a[68:71], v[76:91]
    v_mfma_f32_32x32x16_bf16 v[92:107], a[164:167], a[68:71], 0
    v_mfma_f32_32x32x16_bf16 v[92:107], a[168:171], a[72:75], v[92:107]
    v_mfma_f32_32x32x16_bf16 v[92:107], a[172:175], a[76:79], v[92:107]
    v_add_f32 v240, 0x358637bd, v54
    v_rcp_f32 v240, v240
    s_nop 0
    v_mul_f32 v44, v44, v240
    v_mul_f32 v45, v45, v240
    v_mul_f32 v46, v46, v240
    v_mul_f32 v47, v47, v240
    v_mul_f32 v48, v48, v240
    v_mul_f32 v49, v49, v240
    v_mul_f32 v50, v50, v240
    v_mul_f32 v51, v51, v240
    v_mul_f32 v52, v52, v240
    v_mul_f32 v53, v53, v240
    v_cvt_pk_bf16_f32 v128, v44, v45
    v_cvt_pk_bf16_f32 v129, v46, v47
    v_cvt_pk_bf16_f32 v130, v48, v49
    v_cvt_pk_bf16_f32 v131, v50, v51
    v_cvt_pk_bf16_f32 v132, v52, v53
    v_add_f32 v240, 0x358637bd, v70
    v_rcp_f32 v240, v240
    s_nop 0
    v_mul_f32 v60, v60, v240
    v_mul_f32 v61, v61, v240
    v_mul_f32 v62, v62, v240
    v_mul_f32 v63, v63, v240
    v_mul_f32 v64, v64, v240
    v_mul_f32 v65, v65, v240
    v_mul_f32 v66, v66, v240
    v_mul_f32 v67, v67, v240
    v_mul_f32 v68, v68, v240
    v_mul_f32 v69, v69, v240
    v_cvt_pk_bf16_f32 v133, v60, v61
    v_cvt_pk_bf16_f32 v134, v62, v63
    v_cvt_pk_bf16_f32 v135, v64, v65
    v_cvt_pk_bf16_f32 v136, v66, v67
    v_cvt_pk_bf16_f32 v137, v68, v69
    s_add_u32 s41, s39, 4096
    buffer_load_dwordx4 a[0:3], v3, s[24:27], s41 offen offset:0
    s_add_u32 s41, s39, 12288
    buffer_load_dwordx4 a[4:7], v3, s[24:27], s41 offen offset:2048
    s_add_u32 s41, s39, 24576
    buffer_load_dwordx4 a[8:11], v3, s[24:27], s41 offen offset:0
    s_add_u32 s41, s39, 32768
    buffer_load_dwordx4 a[12:15], v3, s[24:27], s41 offen offset:2048
    s_add_u32 s41, s39, 45056
    buffer_load_dwordx4 a[16:19], v3, s[24:27], s41 offen offset:0
    s_add_u32 s41, s39, 4096
    buffer_load_dwordx4 a[80:83], v3, s[24:27], s41 offen offset:1024
    s_add_u32 s41, s39, 12288
    buffer_load_dwordx4 a[84:87], v3, s[24:27], s41 offen offset:3072
    s_add_u32 s41, s39, 24576
    buffer_load_dwordx4 a[88:91], v3, s[24:27], s41 offen offset:1024
    s_add_u32 s41, s39, 32768
    buffer_load_dwordx4 a[92:95], v3, s[24:27], s41 offen offset:3072
    s_add_u32 s41, s39, 45056
    buffer_load_dwordx4 a[96:99], v3, s[24:27], s41 offen offset:1024
    s_waitcnt vmcnt(30)
    s_cmp_lg_u32 s49, s34
    s_cbranch_scc1 K3_NOYS
    v_add_f32 v192, v192, v196
    v_add_f32 v193, v193, v197
    v_add_f32 v194, v194, v198
    v_add_f32 v195, v195, v199
    v_add_f32 v192, v192, v200
    v_add_f32 v193, v193, v201
    v_add_f32 v194, v194, v202
    v_add_f32 v195, v195, v203
    v_add_f32 v192, v192, v204
    v_add_f32 v193, v193, v205
    v_add_f32 v194, v194, v206
    v_add_f32 v195, v195, v207
    v_add_f32 v192, v192, v208
    v_add_f32 v193, v193, v209
    v_add_f32 v194, v194, v210
    v_add_f32 v195, v195, v211
    v_add_f32 v192, v192, v212
    v_add_f32 v193, v193, v213
    v_add_f32 v194, v194, v214
    v_add_f32 v195, v195, v215
    v_add_f32 v192, v192, v216
    v_add_f32 v193, v193, v217
    v_add_f32 v194, v194, v218
    v_add_f32 v195, v195, v219
    v_add_f32 v192, v192, v220
    v_add_f32 v193, v193, v221
    v_add_f32 v194, v194, v222
    v_add_f32 v195, v195, v223
    v_add_f32 v192, v192, v224
    v_add_f32 v193, v193, v225
    v_add_f32 v194, v194, v226
    v_add_f32 v195, v195, v227
    v_add_f32 v192, v192, v228
    v_add_f32 v193, v193, v229
    v_add_f32 v194, v194, v230
    v_add_f32 v195, v195, v231
    v_add_f32 v192, v192, v232
    v_add_f32 v193, v193, v233
    v_add_f32 v194, v194, v234
    v_add_f32 v195, v195, v235
    v_lshlrev_b32 v4, 4, v0
    v_cmp_gt_u32 vcc, 240, v0
    s_and_saveexec_b64 s[56:57], vcc
    ds_write_b128 v4, v[192:195] offset:0
    s_mov_b64 exec, s[56:57]
K3_NOYS:
    v_lshlrev_b32 v228, 16, v24
    v_and_b32 v229, 0xffff0000, v24
    v_lshlrev_b32 v230, 16, v25
    v_and_b32 v231, 0xffff0000, v25
    v_sub_f32 v228, v228, v34
    v_sub_f32 v229, v229, v34
    v_sub_f32 v230, v230, v34
    v_sub_f32 v231, v231, v34
    v_cvt_pk_bf16_f32 v232, v228, v229
    v_cvt_pk_bf16_f32 v233, v230, v231
    v_lshlrev_b32 v228, 16, v232
    v_and_b32 v229, 0xffff0000, v232
    v_lshlrev_b32 v230, 16, v233
    v_and_b32 v231, 0xffff0000, v233
    v_mul_f32 v228, v228, v35
    v_mul_f32 v229, v229, v35
    v_mul_f32 v230, v230, v35
    v_mul_f32 v231, v231, v35
    v_cvt_pk_bf16_f32 v34, v228, v229
    v_cvt_pk_bf16_f32 v35, v230, v231
    v_lshlrev_b32 v228, 16, v26
    v_and_b32 v229, 0xffff0000, v26
    v_lshlrev_b32 v230, 16, v27
    v_and_b32 v231, 0xffff0000, v27
    v_sub_f32 v228, v228, v36
    v_sub_f32 v229, v229, v36
    v_sub_f32 v230, v230, v36
    v_sub_f32 v231, v231, v36
    v_cvt_pk_bf16_f32 v232, v228, v229
    v_cvt_pk_bf16_f32 v233, v230, v231
    v_lshlrev_b32 v228, 16, v232
    v_and_b32 v229, 0xffff0000, v232
    v_lshlrev_b32 v230, 16, v233
    v_and_b32 v231, 0xffff0000, v233
    v_mul_f32 v228, v228, v37
    v_mul_f32 v229, v229, v37
    v_mul_f32 v230, v230, v37
    v_mul_f32 v231, v231, v37
    v_cvt_pk_bf16_f32 v36, v228, v229
    v_cvt_pk_bf16_f32 v37, v230, v231
    v_lshlrev_b32 v228, 16, v28
    v_and_b32 v229, 0xffff0000, v28
    v_lshlrev_b32 v230, 16, v29
    v_and_b32 v231, 0xffff0000, v29
    v_sub_f32 v228, v228, v38
    v_sub_f32 v229, v229, v38
    v_sub_f32 v230, v230, v38
    v_sub_f32 v231, v231, v38
    v_cvt_pk_bf16_f32 v232, v228, v229
    v_cvt_pk_bf16_f32 v233, v230, v231
    v_lshlrev_b32 v228, 16, v232
    v_and_b32 v229, 0xffff0000, v232
    v_lshlrev_b32 v230, 16, v233
    v_and_b32 v231, 0xffff0000, v233
    v_mul_f32 v228, v228, v39
    v_mul_f32 v229, v229, v39
    v_mul_f32 v230, v230, v39
    v_mul_f32 v231, v231, v39
    v_cvt_pk_bf16_f32 v38, v228, v229
    v_cvt_pk_bf16_f32 v39, v230, v231
    v_lshlrev_b32 v228, 16, v30
    v_and_b32 v229, 0xffff0000, v30
    v_lshlrev_b32 v230, 16, v31
    v_and_b32 v231, 0xffff0000, v31
    v_sub_f32 v228, v228, v40
    v_sub_f32 v229, v229, v40
    v_sub_f32 v230, v230, v40
    v_sub_f32 v231, v231, v40
    v_cvt_pk_bf16_f32 v232, v228, v229
    v_cvt_pk_bf16_f32 v233, v230, v231
    v_lshlrev_b32 v228, 16, v232
    v_and_b32 v229, 0xffff0000, v232
    v_lshlrev_b32 v230, 16, v233
    v_and_b32 v231, 0xffff0000, v233
    v_mul_f32 v228, v228, v41
    v_mul_f32 v229, v229, v41
    v_mul_f32 v230, v230, v41
    v_mul_f32 v231, v231, v41
    v_cvt_pk_bf16_f32 v40, v228, v229
    v_cvt_pk_bf16_f32 v41, v230, v231
    v_lshlrev_b32 v228, 16, v32
    v_and_b32 v229, 0xffff0000, v32
    v_lshlrev_b32 v230, 16, v33
    v_and_b32 v231, 0xffff0000, v33
    v_sub_f32 v228, v228, v42
    v_sub_f32 v229, v229, v42
    v_sub_f32 v230, v230, v42
    v_sub_f32 v231, v231, v42
    v_cvt_pk_bf16_f32 v232, v228, v229
    v_cvt_pk_bf16_f32 v233, v230, v231
    v_lshlrev_b32 v228, 16, v232
    v_and_b32 v229, 0xffff0000, v232
    v_lshlrev_b32 v230, 16, v233
    v_and_b32 v231, 0xffff0000, v233
    v_mul_f32 v228, v228, v43
    v_mul_f32 v229, v229, v43
    v_mul_f32 v230, v230, v43
    v_mul_f32 v231, v231, v43
    v_cvt_pk_bf16_f32 v42, v228, v229
    v_cvt_pk_bf16_f32 v43, v230, v231
    v_add_f32 v240, 0x358637bd, v86
    v_rcp_f32 v240, v240
    s_nop 0
    v_mul_f32 v76, v76, v240
    v_mul_f32 v77, v77, v240
    v_mul_f32 v78, v78, v240
    v_mul_f32 v79, v79, v240
    v_mul_f32 v80, v80, v240
    v_mul_f32 v81, v81, v240
    v_mul_f32 v82, v82, v240
    v_mul_f32 v83, v83, v240
    v_mul_f32 v84, v84, v240
    v_mul_f32 v85, v85, v240
    v_cvt_pk_bf16_f32 v138, v76, v77
    v_cvt_pk_bf16_f32 v139, v78, v79
    v_cvt_pk_bf16_f32 v140, v80, v81
    v_cvt_pk_bf16_f32 v141, v82, v83
    v_cvt_pk_bf16_f32 v142, v84, v85
    v_add_f32 v240, 0x358637bd, v102
    v_rcp_f32 v240, v240
    s_nop 0
    v_mul_f32 v92, v92, v240
    v_mul_f32 v93, v93, v240
    v_mul_f32 v94, v94, v240
    v_mul_f32 v95, v95, v240
    v_mul_f32 v96, v96, v240
    v_mul_f32 v97, v97, v240
    v_mul_f32 v98, v98, v240
    v_mul_f32 v99, v99, v240
    v_mul_f32 v100, v100, v240
    v_mul_f32 v101, v101, v240
    v_cvt_pk_bf16_f32 v143, v92, v93
    v_cvt_pk_bf16_f32 v144, v94, v95
    v_cvt_pk_bf16_f32 v145, v96, v97
    v_cvt_pk_bf16_f32 v146, v98, v99
    v_cvt_pk_bf16_f32 v147, v100, v101
    s_nop 1
    s_waitcnt vmcnt(25)
    v_mfma_f32_32x32x16_bf16 v[148:163], a[176:179], v[108:111], 0
    v_mfma_f32_32x32x16_bf16 v[164:179], a[180:183], v[108:111], 0
    v_mfma_f32_32x32x16_bf16 v[180:195], a[184:187], v[108:111], 0
    v_mfma_f32_32x32x16_bf16 v[196:211], a[188:191], v[108:111], 0
    v_mfma_f32_32x32x16_bf16 v[212:227], a[192:195], v[108:111], 0
    s_add_u32 s41, s39, 4096
    buffer_load_dwordx4 a[100:103], v3, s[24:27], s41 offen offset:2048
    s_add_u32 s41, s39, 16384
    buffer_load_dwordx4 a[20:23], v3, s[24:27], s41 offen offset:0
    s_add_u32 s41, s39, 24576
    buffer_load_dwordx4 a[24:27], v3, s[24:27], s41 offen offset:2048
    s_add_u32 s41, s39, 36864
    buffer_load_dwordx4 a[28:31], v3, s[24:27], s41 offen offset:0
    s_add_u32 s41, s39, 45056
    buffer_load_dwordx4 a[32:35], v3, s[24:27], s41 offen offset:2048
    s_waitcnt vmcnt(25)
    v_mfma_f32_32x32x16_bf16 v[148:163], a[196:199], v[112:115], v[148:163]
    v_mfma_f32_32x32x16_bf16 v[164:179], a[200:203], v[112:115], v[164:179]
    v_mfma_f32_32x32x16_bf16 v[180:195], a[204:207], v[112:115], v[180:195]
    v_mfma_f32_32x32x16_bf16 v[196:211], a[208:211], v[112:115], v[196:211]
    v_mfma_f32_32x32x16_bf16 v[212:227], a[212:215], v[112:115], v[212:227]
    s_add_u32 s41, s39, 4096
    buffer_load_dwordx4 a[36:39], v3, s[24:27], s41 offen offset:3072
    s_add_u32 s41, s39, 16384
    buffer_load_dwordx4 a[104:107], v3, s[24:27], s41 offen offset:1024
    s_add_u32 s41, s39, 24576
    buffer_load_dwordx4 a[108:111], v3, s[24:27], s41 offen offset:3072
    s_add_u32 s41, s39, 36864
    buffer_load_dwordx4 a[112:115], v3, s[24:27], s41 offen offset:1024
    s_add_u32 s41, s39, 45056
    buffer_load_dwordx4 a[116:119], v3, s[24:27], s41 offen offset:3072
    s_waitcnt vmcnt(25)
    v_mfma_f32_32x32x16_bf16 v[148:163], a[216:219], v[116:119], v[148:163]
    v_mfma_f32_32x32x16_bf16 v[164:179], a[220:223], v[116:119], v[164:179]
    v_mfma_f32_32x32x16_bf16 v[180:195], a[224:227], v[116:119], v[180:195]
    v_mfma_f32_32x32x16_bf16 v[196:211], a[228:231], v[116:119], v[196:211]
    v_mfma_f32_32x32x16_bf16 v[212:227], a[232:235], v[116:119], v[212:227]
    s_add_u32 s41, s39, 8192
    buffer_load_dwordx4 a[120:123], v3, s[24:27], s41 offen offset:0
    s_add_u32 s41, s39, 16384
    buffer_load_dwordx4 a[124:127], v3, s[24:27], s41 offen offset:2048
    s_add_u32 s41, s39, 28672
    buffer_load_dwordx4 a[40:43], v3, s[24:27], s41 offen offset:0
    s_add_u32 s41, s39, 36864
    buffer_load_dwordx4 a[44:47], v3, s[24:27], s41 offen offset:2048
    s_add_u32 s41, s39, 49152
    buffer_load_dwordx4 a[48:51], v3, s[24:27], s41 offen offset:0
    s_waitcnt vmcnt(25)
    v_mfma_f32_32x32x16_bf16 v[148:163], a[236:239], v[120:123], v[148:163]
    v_mfma_f32_32x32x16_bf16 v[164:179], a[240:243], v[120:123], v[164:179]
    v_mfma_f32_32x32x16_bf16 v[180:195], a[244:247], v[120:123], v[180:195]
    v_mfma_f32_32x32x16_bf16 v[196:211], a[248:251], v[120:123], v[196:211]
    v_mfma_f32_32x32x16_bf16 v[212:227], a[252:255], v[120:123], v[212:227]
    s_add_u32 s41, s39, 8192
    buffer_load_dwordx4 a[52:55], v3, s[24:27], s41 offen offset:1024
    s_add_u32 s41, s39, 16384
    buffer_load_dwordx4 a[56:59], v3, s[24:27], s41 offen offset:3072
    s_add_u32 s41, s39, 28672
    buffer_load_dwordx4 a[128:131], v3, s[24:27], s41 offen offset:1024
    s_add_u32 s41, s39, 36864
    buffer_load_dwordx4 a[132:135], v3, s[24:27], s41 offen offset:3072
    s_add_u32 s41, s39, 49152
    buffer_load_dwordx4 a[136:139], v3, s[24:27], s41 offen offset:1024
    s_waitcnt vmcnt(25)
    v_mfma_f32_32x32x16_bf16 v[148:163], a[0:3], v[124:127], v[148:163]
    v_mfma_f32_32x32x16_bf16 v[164:179], a[4:7], v[124:127], v[164:179]
    v_mfma_f32_32x32x16_bf16 v[180:195], a[8:11], v[124:127], v[180:195]
    v_mfma_f32_32x32x16_bf16 v[196:211], a[12:15], v[124:127], v[196:211]
    v_mfma_f32_32x32x16_bf16 v[212:227], a[16:19], v[124:127], v[212:227]
    s_waitcnt vmcnt(20)
    v_mfma_f32_32x32x16_bf16 v[148:163], a[80:83], v[128:131], v[148:163]
    v_mfma_f32_32x32x16_bf16 v[164:179], a[84:87], v[128:131], v[164:179]
    v_mfma_f32_32x32x16_bf16 v[180:195], a[88:91], v[128:131], v[180:195]
    v_mfma_f32_32x32x16_bf16 v[196:211], a[92:95], v[128:131], v[196:211]
    v_mfma_f32_32x32x16_bf16 v[212:227], a[96:99], v[128:131], v[212:227]
    s_waitcnt vmcnt(15)
    v_mfma_f32_32x32x16_bf16 v[148:163], a[100:103], v[132:135], v[148:163]
    v_mfma_f32_32x32x16_bf16 v[164:179], a[20:23], v[132:135], v[164:179]
    v_mfma_f32_32x32x16_bf16 v[180:195], a[24:27], v[132:135], v[180:195]
    v_mfma_f32_32x32x16_bf16 v[196:211], a[28:31], v[132:135], v[196:211]
    v_mfma_f32_32x32x16_bf16 v[212:227], a[32:35], v[132:135], v[212:227]
    s_waitcnt vmcnt(10)
    v_mfma_f32_32x32x16_bf16 v[148:163], a[36:39], v[136:139], v[148:163]
    v_mfma_f32_32x32x16_bf16 v[164:179], a[104:107], v[136:139], v[164:179]
    v_mfma_f32_32x32x16_bf16 v[180:195], a[108:111], v[136:139], v[180:195]
    v_mfma_f32_32x32x16_bf16 v[196:211], a[112:115], v[136:139], v[196:211]
    v_mfma_f32_32x32x16_bf16 v[212:227], a[116:119], v[136:139], v[212:227]
    s_waitcnt vmcnt(5)
    v_mfma_f32_32x32x16_bf16 v[148:163], a[120:123], v[140:143], v[148:163]
    v_mfma_f32_32x32x16_bf16 v[164:179], a[124:127], v[140:143], v[164:179]
    v_mfma_f32_32x32x16_bf16 v[180:195], a[40:43], v[140:143], v[180:195]
    v_mfma_f32_32x32x16_bf16 v[196:211], a[44:47], v[140:143], v[196:211]
    v_mfma_f32_32x32x16_bf16 v[212:227], a[48:51], v[140:143], v[212:227]
    s_waitcnt vmcnt(0)
    v_mfma_f32_32x32x16_bf16 v[148:163], a[52:55], v[144:147], v[148:163]
    v_mfma_f32_32x32x16_bf16 v[164:179], a[56:59], v[144:147], v[164:179]
    v_mfma_f32_32x32x16_bf16 v[180:195], a[128:131], v[144:147], v[180:195]
    v_mfma_f32_32x32x16_bf16 v[196:211], a[132:135], v[144:147], v[196:211]
    v_mfma_f32_32x32x16_bf16 v[212:227], a[136:139], v[144:147], v[212:227]
K3_P2E:
    v_and_b32 v4, 31, v2
    v_mul_u32_u24 v4, 656, v4
    v_lshrrev_b32 v5, 5, v2
    v_lshl_add_u32 v4, v5, 4, v4
    s_mul_i32 s50, s30, 20992
    s_add_u32 s50, s50, 4608
    v_add_u32 v4, s50, v4
    s_nop 7
    ds_write_b128 v4, v[148:151] offset:0
    ds_write_b128 v4, v[152:155] offset:32
    ds_write_b128 v4, v[156:159] offset:64
    ds_write_b128 v4, v[160:163] offset:96
    ds_write_b128 v4, v[164:167] offset:128
    ds_write_b128 v4, v[168:171] offset:160
    ds_write_b128 v4, v[172:175] offset:192
    ds_write_b128 v4, v[176:179] offset:224
    ds_write_b128 v4, v[180:183] offset:256
    ds_write_b128 v4, v[184:187] offset:288
    ds_write_b128 v4, v[188:191] offset:320
    ds_write_b128 v4, v[192:195] offset:352
    ds_write_b128 v4, v[196:199] offset:384
    ds_write_b128 v4, v[200:203] offset:416
    ds_write_b128 v4, v[204:207] offset:448
    ds_write_b128 v4, v[208:211] offset:480
    ds_write_b128 v4, v[212:215] offset:512
    ds_write_b128 v4, v[216:219] offset:544
    ds_write_b128 v4, v[220:223] offset:576
    ds_write_b128 v4, v[224:227] offset:608
    s_waitcnt lgkmcnt(0)
    s_barrier
    v_subrev_u32 v4, s35, v8
    v_mul_u32_u24 v4, 656, v4
    v_lshl_add_u32 v4, v13, 4, v4
    v_add_u32 v4, 4608, v4
    ds_read_b128 v[44:47], v4 offset:0
    ds_read_b128 v[48:51], v4 offset:20992
    ds_read_b128 v[52:55], v4 offset:41984
    ds_read_b128 v[56:59], v4 offset:62976
    v_subrev_u32 v4, s35, v9
    v_mul_u32_u24 v4, 656, v4
    v_lshl_add_u32 v4, v14, 4, v4
    v_add_u32 v4, 4608, v4
    ds_read_b128 v[60:63], v4 offset:0
    ds_read_b128 v[64:67], v4 offset:20992
    ds_read_b128 v[68:71], v4 offset:41984
    ds_read_b128 v[72:75], v4 offset:62976
    v_subrev_u32 v4, s35, v10
    v_mul_u32_u24 v4, 656, v4
    v_lshl_add_u32 v4, v15, 4, v4
    v_add_u32 v4, 4608, v4
    ds_read_b128 v[76:79], v4 offset:0
    ds_read_b128 v[80:83], v4 offset:20992
    ds_read_b128 v[84:87], v4 offset:41984
    ds_read_b128 v[88:91], v4 offset:62976
    v_subrev_u32 v4, s35, v11
    v_mul_u32_u24 v4, 656, v4
    v_lshl_add_u32 v4, v16, 4, v4
    v_add_u32 v4, 4608, v4
    ds_read_b128 v[92:95], v4 offset:0
    ds_read_b128 v[96:99], v4 offset:20992
    ds_read_b128 v[100:103], v4 offset:41984
    ds_read_b128 v[104:107], v4 offset:62976
    v_subrev_u32 v4, s35, v12
    v_mul_u32_u24 v4, 656, v4
    v_lshl_add_u32 v4, v17, 4, v4
    v_add_u32 v4, 4608, v4
    ds_read_b128 v[108:111], v4 offset:0
    ds_read_b128 v[112:115], v4 offset:20992
    ds_read_b128 v[116:119], v4 offset:41984
    ds_read_b128 v[120:123], v4 offset:62976
    s_cmp_lg_u32 s49, s34
    s_cbranch_scc1 K3_NOY
    s_mov_b32 s60, 0x3fb8aa3b
    v_mov_b32 v232, s48
    v_mul_f32 v232, s60, v232
    v_exp_f32 v232, -v232
    s_nop 0
    v_add_f32 v232, 1.0, v232
    v_rcp_f32 v232, v232
    s_nop 0
    v_cvt_pk_bf16_f32 v232, v232, v232
    v_lshlrev_b32 v232, 16, v232
    v_cmp_eq_u32 vcc, s47, v8
    s_and_saveexec_b64 s[56:57], vcc
    s_cbranch_execz K3_YS0
    v_lshlrev_b32 v5, 4, v13
    ds_read_b128 v[128:131], v5 offset:0
    ds_read_b128 v[132:135], v5 offset:640
    ds_read_b128 v[136:139], v5 offset:1280
    ds_read_b128 v[140:143], v5 offset:1920
    ds_read_b128 v[144:147], v5 offset:2560
    ds_read_b128 v[148:151], v5 offset:3200
    s_waitcnt lgkmcnt(0)
    v_add_f32 v128, v128, v132
    v_add_f32 v129, v129, v133
    v_add_f32 v130, v130, v134
    v_add_f32 v131, v131, v135
    v_add_f32 v128, v128, v136
    v_add_f32 v129, v129, v137
    v_add_f32 v130, v130, v138
    v_add_f32 v131, v131, v139
    v_add_f32 v128, v128, v140
    v_add_f32 v129, v129, v141
    v_add_f32 v130, v130, v142
    v_add_f32 v131, v131, v143
    v_add_f32 v128, v128, v144
    v_add_f32 v129, v129, v145
    v_add_f32 v130, v130, v146
    v_add_f32 v131, v131, v147
    v_add_f32 v128, v128, v148
    v_add_f32 v129, v129, v149
    v_add_f32 v130, v130, v150
    v_add_f32 v131, v131, v151
    v_lshlrev_b32 v228, 16, v34
    v_and_b32 v229, 0xffff0000, v34
    v_lshlrev_b32 v230, 16, v35
    v_and_b32 v231, 0xffff0000, v35
    v_cvt_pk_bf16_f32 v128, v128, v128
    v_lshlrev_b32 v128, 16, v128
    v_mul_f32 v128, v128, v232
    v_cvt_pk_bf16_f32 v128, v128, v128
    v_lshlrev_b32 v128, 16, v128
    v_add_f32 v228, v228, v128
    v_cvt_pk_bf16_f32 v129, v129, v129
    v_lshlrev_b32 v129, 16, v129
    v_mul_f32 v129, v129, v232
    v_cvt_pk_bf16_f32 v129, v129, v129
    v_lshlrev_b32 v129, 16, v129
    v_add_f32 v229, v229, v129
    v_cvt_pk_bf16_f32 v130, v130, v130
    v_lshlrev_b32 v130, 16, v130
    v_mul_f32 v130, v130, v232
    v_cvt_pk_bf16_f32 v130, v130, v130
    v_lshlrev_b32 v130, 16, v130
    v_add_f32 v230, v230, v130
    v_cvt_pk_bf16_f32 v131, v131, v131
    v_lshlrev_b32 v131, 16, v131
    v_mul_f32 v131, v131, v232
    v_cvt_pk_bf16_f32 v131, v131, v131
    v_lshlrev_b32 v131, 16, v131
    v_add_f32 v231, v231, v131
    v_cvt_pk_bf16_f32 v34, v228, v229
    v_cvt_pk_bf16_f32 v35, v230, v231
K3_YS0:
    s_mov_b64 exec, s[56:57]
    v_cmp_eq_u32 vcc, s47, v9
    s_and_saveexec_b64 s[56:57], vcc
    s_cbranch_execz K3_YS1
    v_lshlrev_b32 v5, 4, v14
    ds_read_b128 v[128:131], v5 offset:0
    ds_read_b128 v[132:135], v5 offset:640
    ds_read_b128 v[136:139], v5 offset:1280
    ds_read_b128 v[140:143], v5 offset:1920
    ds_read_b128 v[144:147], v5 offset:2560
    ds_read_b128 v[148:151], v5 offset:3200
    s_waitcnt lgkmcnt(0)
    v_add_f32 v128, v128, v132
    v_add_f32 v129, v129, v133
    v_add_f32 v130, v130, v134
    v_add_f32 v131, v131, v135
    v_add_f32 v128, v128, v136
    v_add_f32 v129, v129, v137
    v_add_f32 v130, v130, v138
    v_add_f32 v131, v131, v139
    v_add_f32 v128, v128, v140
    v_add_f32 v129, v129, v141
    v_add_f32 v130, v130, v142
    v_add_f32 v131, v131, v143
    v_add_f32 v128, v128, v144
    v_add_f32 v129, v129, v145
    v_add_f32 v130, v130, v146
    v_add_f32 v131, v131, v147
    v_add_f32 v128, v128, v148
    v_add_f32 v129, v129, v149
    v_add_f32 v130, v130, v150
    v_add_f32 v131, v131, v151
    v_lshlrev_b32 v228, 16, v36
    v_and_b32 v229, 0xffff0000, v36
    v_lshlrev_b32 v230, 16, v37
    v_and_b32 v231, 0xffff0000, v37
    v_cvt_pk_bf16_f32 v128, v128, v128
    v_lshlrev_b32 v128, 16, v128
    v_mul_f32 v128, v128, v232
    v_cvt_pk_bf16_f32 v128, v128, v128
    v_lshlrev_b32 v128, 16, v128
    v_add_f32 v228, v228, v128
    v_cvt_pk_bf16_f32 v129, v129, v129
    v_lshlrev_b32 v129, 16, v129
    v_mul_f32 v129, v129, v232
    v_cvt_pk_bf16_f32 v129, v129, v129
    v_lshlrev_b32 v129, 16, v129
    v_add_f32 v229, v229, v129
    v_cvt_pk_bf16_f32 v130, v130, v130
    v_lshlrev_b32 v130, 16, v130
    v_mul_f32 v130, v130, v232
    v_cvt_pk_bf16_f32 v130, v130, v130
    v_lshlrev_b32 v130, 16, v130
    v_add_f32 v230, v230, v130
    v_cvt_pk_bf16_f32 v131, v131, v131
    v_lshlrev_b32 v131, 16, v131
    v_mul_f32 v131, v131, v232
    v_cvt_pk_bf16_f32 v131, v131, v131
    v_lshlrev_b32 v131, 16, v131
    v_add_f32 v231, v231, v131
    v_cvt_pk_bf16_f32 v36, v228, v229
    v_cvt_pk_bf16_f32 v37, v230, v231
K3_YS1:
    s_mov_b64 exec, s[56:57]
    v_cmp_eq_u32 vcc, s47, v10
    s_and_saveexec_b64 s[56:57], vcc
    s_cbranch_execz K3_YS2
    v_lshlrev_b32 v5, 4, v15
    ds_read_b128 v[128:131], v5 offset:0
    ds_read_b128 v[132:135], v5 offset:640
    ds_read_b128 v[136:139], v5 offset:1280
    ds_read_b128 v[140:143], v5 offset:1920
    ds_read_b128 v[144:147], v5 offset:2560
    ds_read_b128 v[148:151], v5 offset:3200
    s_waitcnt lgkmcnt(0)
    v_add_f32 v128, v128, v132
    v_add_f32 v129, v129, v133
    v_add_f32 v130, v130, v134
    v_add_f32 v131, v131, v135
    v_add_f32 v128, v128, v136
    v_add_f32 v129, v129, v137
    v_add_f32 v130, v130, v138
    v_add_f32 v131, v131, v139
    v_add_f32 v128, v128, v140
    v_add_f32 v129, v129, v141
    v_add_f32 v130, v130, v142
    v_add_f32 v131, v131, v143
    v_add_f32 v128, v128, v144
    v_add_f32 v129, v129, v145
    v_add_f32 v130, v130, v146
    v_add_f32 v131, v131, v147
    v_add_f32 v128, v128, v148
    v_add_f32 v129, v129, v149
    v_add_f32 v130, v130, v150
    v_add_f32 v131, v131, v151
    v_lshlrev_b32 v228, 16, v38
    v_and_b32 v229, 0xffff0000, v38
    v_lshlrev_b32 v230, 16, v39
    v_and_b32 v231, 0xffff0000, v39
    v_cvt_pk_bf16_f32 v128, v128, v128
    v_lshlrev_b32 v128, 16, v128
    v_mul_f32 v128, v128, v232
    v_cvt_pk_bf16_f32 v128, v128, v128
    v_lshlrev_b32 v128, 16, v128
    v_add_f32 v228, v228, v128
    v_cvt_pk_bf16_f32 v129, v129, v129
    v_lshlrev_b32 v129, 16, v129
    v_mul_f32 v129, v129, v232
    v_cvt_pk_bf16_f32 v129, v129, v129
    v_lshlrev_b32 v129, 16, v129
    v_add_f32 v229, v229, v129
    v_cvt_pk_bf16_f32 v130, v130, v130
    v_lshlrev_b32 v130, 16, v130
    v_mul_f32 v130, v130, v232
    v_cvt_pk_bf16_f32 v130, v130, v130
    v_lshlrev_b32 v130, 16, v130
    v_add_f32 v230, v230, v130
    v_cvt_pk_bf16_f32 v131, v131, v131
    v_lshlrev_b32 v131, 16, v131
    v_mul_f32 v131, v131, v232
    v_cvt_pk_bf16_f32 v131, v131, v131
    v_lshlrev_b32 v131, 16, v131
    v_add_f32 v231, v231, v131
    v_cvt_pk_bf16_f32 v38, v228, v229
    v_cvt_pk_bf16_f32 v39, v230, v231
K3_YS2:
    s_mov_b64 exec, s[56:57]
    v_cmp_eq_u32 vcc, s47, v11
    s_and_saveexec_b64 s[56:57], vcc
    s_cbranch_execz K3_YS3
    v_lshlrev_b32 v5, 4, v16
    ds_read_b128 v[128:131], v5 offset:0
    ds_read_b128 v[132:135], v5 offset:640
    ds_read_b128 v[136:139], v5 offset:1280
    ds_read_b128 v[140:143], v5 offset:1920
    ds_read_b128 v[144:147], v5 offset:2560
    ds_read_b128 v[148:151], v5 offset:3200
    s_waitcnt lgkmcnt(0)
    v_add_f32 v128, v128, v132
    v_add_f32 v129, v129, v133
    v_add_f32 v130, v130, v134
    v_add_f32 v131, v131, v135
    v_add_f32 v128, v128, v136
    v_add_f32 v129, v129, v137
    v_add_f32 v130, v130, v138
    v_add_f32 v131, v131, v139
    v_add_f32 v128, v128, v140
    v_add_f32 v129, v129, v141
    v_add_f32 v130, v130, v142
    v_add_f32 v131, v131, v143
    v_add_f32 v128, v128, v144
    v_add_f32 v129, v129, v145
    v_add_f32 v130, v130, v146
    v_add_f32 v131, v131, v147
    v_add_f32 v128, v128, v148
    v_add_f32 v129, v129, v149
    v_add_f32 v130, v130, v150
    v_add_f32 v131, v131, v151
    v_lshlrev_b32 v228, 16, v40
    v_and_b32 v229, 0xffff0000, v40
    v_lshlrev_b32 v230, 16, v41
    v_and_b32 v231, 0xffff0000, v41
    v_cvt_pk_bf16_f32 v128, v128, v128
    v_lshlrev_b32 v128, 16, v128
    v_mul_f32 v128, v128, v232
    v_cvt_pk_bf16_f32 v128, v128, v128
    v_lshlrev_b32 v128, 16, v128
    v_add_f32 v228, v228, v128
    v_cvt_pk_bf16_f32 v129, v129, v129
    v_lshlrev_b32 v129, 16, v129
    v_mul_f32 v129, v129, v232
    v_cvt_pk_bf16_f32 v129, v129, v129
    v_lshlrev_b32 v129, 16, v129
    v_add_f32 v229, v229, v129
    v_cvt_pk_bf16_f32 v130, v130, v130
    v_lshlrev_b32 v130, 16, v130
    v_mul_f32 v130, v130, v232
    v_cvt_pk_bf16_f32 v130, v130, v130
    v_lshlrev_b32 v130, 16, v130
    v_add_f32 v230, v230, v130
    v_cvt_pk_bf16_f32 v131, v131, v131
    v_lshlrev_b32 v131, 16, v131
    v_mul_f32 v131, v131, v232
    v_cvt_pk_bf16_f32 v131, v131, v131
    v_lshlrev_b32 v131, 16, v131
    v_add_f32 v231, v231, v131
    v_cvt_pk_bf16_f32 v40, v228, v229
    v_cvt_pk_bf16_f32 v41, v230, v231
K3_YS3:
    s_mov_b64 exec, s[56:57]
    v_cmp_eq_u32 vcc, s47, v12
    s_and_saveexec_b64 s[56:57], vcc
    s_cbranch_execz K3_YS4
    v_lshlrev_b32 v5, 4, v17
    ds_read_b128 v[128:131], v5 offset:0
    ds_read_b128 v[132:135], v5 offset:640
    ds_read_b128 v[136:139], v5 offset:1280
    ds_read_b128 v[140:143], v5 offset:1920
    ds_read_b128 v[144:147], v5 offset:2560
    ds_read_b128 v[148:151], v5 offset:3200
    s_waitcnt lgkmcnt(0)
    v_add_f32 v128, v128, v132
    v_add_f32 v129, v129, v133
    v_add_f32 v130, v130, v134
    v_add_f32 v131, v131, v135
    v_add_f32 v128, v128, v136
    v_add_f32 v129, v129, v137
    v_add_f32 v130, v130, v138
    v_add_f32 v131, v131, v139
    v_add_f32 v128, v128, v140
    v_add_f32 v129, v129, v141
    v_add_f32 v130, v130, v142
    v_add_f32 v131, v131, v143
    v_add_f32 v128, v128, v144
    v_add_f32 v129, v129, v145
    v_add_f32 v130, v130, v146
    v_add_f32 v131, v131, v147
    v_add_f32 v128, v128, v148
    v_add_f32 v129, v129, v149
    v_add_f32 v130, v130, v150
    v_add_f32 v131, v131, v151
    v_lshlrev_b32 v228, 16, v42
    v_and_b32 v229, 0xffff0000, v42
    v_lshlrev_b32 v230, 16, v43
    v_and_b32 v231, 0xffff0000, v43
    v_cvt_pk_bf16_f32 v128, v128, v128
    v_lshlrev_b32 v128, 16, v128
    v_mul_f32 v128, v128, v232
    v_cvt_pk_bf16_f32 v128, v128, v128
    v_lshlrev_b32 v128, 16, v128
    v_add_f32 v228, v228, v128
    v_cvt_pk_bf16_f32 v129, v129, v129
    v_lshlrev_b32 v129, 16, v129
    v_mul_f32 v129, v129, v232
    v_cvt_pk_bf16_f32 v129, v129, v129
    v_lshlrev_b32 v129, 16, v129
    v_add_f32 v229, v229, v129
    v_cvt_pk_bf16_f32 v130, v130, v130
    v_lshlrev_b32 v130, 16, v130
    v_mul_f32 v130, v130, v232
    v_cvt_pk_bf16_f32 v130, v130, v130
    v_lshlrev_b32 v130, 16, v130
    v_add_f32 v230, v230, v130
    v_cvt_pk_bf16_f32 v131, v131, v131
    v_lshlrev_b32 v131, 16, v131
    v_mul_f32 v131, v131, v232
    v_cvt_pk_bf16_f32 v131, v131, v131
    v_lshlrev_b32 v131, 16, v131
    v_add_f32 v231, v231, v131
    v_cvt_pk_bf16_f32 v42, v228, v229
    v_cvt_pk_bf16_f32 v43, v230, v231
K3_YS4:
    s_mov_b64 exec, s[56:57]
K3_NOY:
    s_waitcnt lgkmcnt(0)
    v_add_f32 v44, v44, v48
    v_add_f32 v52, v52, v56
    v_add_f32 v44, v44, v52
    v_add_f32 v45, v45, v49
    v_add_f32 v53, v53, v57
    v_add_f32 v45, v45, v53
    v_add_f32 v46, v46, v50
    v_add_f32 v54, v54, v58
    v_add_f32 v46, v46, v54
    v_add_f32 v47, v47, v51
    v_add_f32 v55, v55, v59
    v_add_f32 v47, v47, v55
    v_cvt_pk_bf16_f32 v232, v44, v45
    v_cvt_pk_bf16_f32 v233, v46, v47
    v_lshlrev_b32 v44, 16, v232
    v_and_b32 v45, 0xffff0000, v232
    v_lshlrev_b32 v46, 16, v233
    v_and_b32 v47, 0xffff0000, v233
    v_lshlrev_b32 v228, 16, v24
    v_and_b32 v229, 0xffff0000, v24
    v_lshlrev_b32 v230, 16, v25
    v_and_b32 v231, 0xffff0000, v25
    v_add_f32 v44, v44, v228
    v_add_f32 v45, v45, v229
    v_add_f32 v46, v46, v230
    v_add_f32 v47, v47, v231
    v_cvt_pk_bf16_f32 v232, v44, v45
    v_cvt_pk_bf16_f32 v233, v46, v47
    v_lshlrev_b32 v44, 16, v232
    v_and_b32 v45, 0xffff0000, v232
    v_lshlrev_b32 v46, 16, v233
    v_and_b32 v47, 0xffff0000, v233
    v_lshlrev_b32 v228, 16, v34
    v_and_b32 v229, 0xffff0000, v34
    v_lshlrev_b32 v230, 16, v35
    v_and_b32 v231, 0xffff0000, v35
    v_add_f32 v44, v44, v228
    v_add_f32 v45, v45, v229
    v_add_f32 v46, v46, v230
    v_add_f32 v47, v47, v231
    v_cvt_pk_bf16_f32 v48, v44, v45
    v_cvt_pk_bf16_f32 v49, v46, v47
    buffer_store_dwordx2 v[48:49], v18, s[20:23], 0 offen sc0 sc1
    v_add_f32 v60, v60, v64
    v_add_f32 v68, v68, v72
    v_add_f32 v60, v60, v68
    v_add_f32 v61, v61, v65
    v_add_f32 v69, v69, v73
    v_add_f32 v61, v61, v69
    v_add_f32 v62, v62, v66
    v_add_f32 v70, v70, v74
    v_add_f32 v62, v62, v70
    v_add_f32 v63, v63, v67
    v_add_f32 v71, v71, v75
    v_add_f32 v63, v63, v71
    v_cvt_pk_bf16_f32 v232, v60, v61
    v_cvt_pk_bf16_f32 v233, v62, v63
    v_lshlrev_b32 v60, 16, v232
    v_and_b32 v61, 0xffff0000, v232
    v_lshlrev_b32 v62, 16, v233
    v_and_b32 v63, 0xffff0000, v233
    v_lshlrev_b32 v228, 16, v26
    v_and_b32 v229, 0xffff0000, v26
    v_lshlrev_b32 v230, 16, v27
    v_and_b32 v231, 0xffff0000, v27
    v_add_f32 v60, v60, v228
    v_add_f32 v61, v61, v229
    v_add_f32 v62, v62, v230
    v_add_f32 v63, v63, v231
    v_cvt_pk_bf16_f32 v232, v60, v61
    v_cvt_pk_bf16_f32 v233, v62, v63
    v_lshlrev_b32 v60, 16, v232
    v_and_b32 v61, 0xffff0000, v232
    v_lshlrev_b32 v62, 16, v233
    v_and_b32 v63, 0xffff0000, v233
    v_lshlrev_b32 v228, 16, v36
    v_and_b32 v229, 0xffff0000, v36
    v_lshlrev_b32 v230, 16, v37
    v_and_b32 v231, 0xffff0000, v37
    v_add_f32 v60, v60, v228
    v_add_f32 v61, v61, v229
    v_add_f32 v62, v62, v230
    v_add_f32 v63, v63, v231
    v_cvt_pk_bf16_f32 v64, v60, v61
    v_cvt_pk_bf16_f32 v65, v62, v63
    buffer_store_dwordx2 v[64:65], v19, s[20:23], 0 offen sc0 sc1
    v_add_f32 v76, v76, v80
    v_add_f32 v84, v84, v88
    v_add_f32 v76, v76, v84
    v_add_f32 v77, v77, v81
    v_add_f32 v85, v85, v89
    v_add_f32 v77, v77, v85
    v_add_f32 v78, v78, v82
    v_add_f32 v86, v86, v90
    v_add_f32 v78, v78, v86
    v_add_f32 v79, v79, v83
    v_add_f32 v87, v87, v91
    v_add_f32 v79, v79, v87
    v_cvt_pk_bf16_f32 v232, v76, v77
    v_cvt_pk_bf16_f32 v233, v78, v79
    v_lshlrev_b32 v76, 16, v232
    v_and_b32 v77, 0xffff0000, v232
    v_lshlrev_b32 v78, 16, v233
    v_and_b32 v79, 0xffff0000, v233
    v_lshlrev_b32 v228, 16, v28
    v_and_b32 v229, 0xffff0000, v28
    v_lshlrev_b32 v230, 16, v29
    v_and_b32 v231, 0xffff0000, v29
    v_add_f32 v76, v76, v228
    v_add_f32 v77, v77, v229
    v_add_f32 v78, v78, v230
    v_add_f32 v79, v79, v231
    v_cvt_pk_bf16_f32 v232, v76, v77
    v_cvt_pk_bf16_f32 v233, v78, v79
    v_lshlrev_b32 v76, 16, v232
    v_and_b32 v77, 0xffff0000, v232
    v_lshlrev_b32 v78, 16, v233
    v_and_b32 v79, 0xffff0000, v233
    v_lshlrev_b32 v228, 16, v38
    v_and_b32 v229, 0xffff0000, v38
    v_lshlrev_b32 v230, 16, v39
    v_and_b32 v231, 0xffff0000, v39
    v_add_f32 v76, v76, v228
    v_add_f32 v77, v77, v229
    v_add_f32 v78, v78, v230
    v_add_f32 v79, v79, v231
    v_cvt_pk_bf16_f32 v80, v76, v77
    v_cvt_pk_bf16_f32 v81, v78, v79
    buffer_store_dwordx2 v[80:81], v20, s[20:23], 0 offen sc0 sc1
    v_add_f32 v92, v92, v96
    v_add_f32 v100, v100, v104
    v_add_f32 v92, v92, v100
    v_add_f32 v93, v93, v97
    v_add_f32 v101, v101, v105
    v_add_f32 v93, v93, v101
    v_add_f32 v94, v94, v98
    v_add_f32 v102, v102, v106
    v_add_f32 v94, v94, v102
    v_add_f32 v95, v95, v99
    v_add_f32 v103, v103, v107
    v_add_f32 v95, v95, v103
    v_cvt_pk_bf16_f32 v232, v92, v93
    v_cvt_pk_bf16_f32 v233, v94, v95
    v_lshlrev_b32 v92, 16, v232
    v_and_b32 v93, 0xffff0000, v232
    v_lshlrev_b32 v94, 16, v233
    v_and_b32 v95, 0xffff0000, v233
    v_lshlrev_b32 v228, 16, v30
    v_and_b32 v229, 0xffff0000, v30
    v_lshlrev_b32 v230, 16, v31
    v_and_b32 v231, 0xffff0000, v31
    v_add_f32 v92, v92, v228
    v_add_f32 v93, v93, v229
    v_add_f32 v94, v94, v230
    v_add_f32 v95, v95, v231
    v_cvt_pk_bf16_f32 v232, v92, v93
    v_cvt_pk_bf16_f32 v233, v94, v95
    v_lshlrev_b32 v92, 16, v232
    v_and_b32 v93, 0xffff0000, v232
    v_lshlrev_b32 v94, 16, v233
    v_and_b32 v95, 0xffff0000, v233
    v_lshlrev_b32 v228, 16, v40
    v_and_b32 v229, 0xffff0000, v40
    v_lshlrev_b32 v230, 16, v41
    v_and_b32 v231, 0xffff0000, v41
    v_add_f32 v92, v92, v228
    v_add_f32 v93, v93, v229
    v_add_f32 v94, v94, v230
    v_add_f32 v95, v95, v231
    v_cvt_pk_bf16_f32 v96, v92, v93
    v_cvt_pk_bf16_f32 v97, v94, v95
    buffer_store_dwordx2 v[96:97], v21, s[20:23], 0 offen sc0 sc1
    v_add_f32 v108, v108, v112
    v_add_f32 v116, v116, v120
    v_add_f32 v108, v108, v116
    v_add_f32 v109, v109, v113
    v_add_f32 v117, v117, v121
    v_add_f32 v109, v109, v117
    v_add_f32 v110, v110, v114
    v_add_f32 v118, v118, v122
    v_add_f32 v110, v110, v118
    v_add_f32 v111, v111, v115
    v_add_f32 v119, v119, v123
    v_add_f32 v111, v111, v119
    v_cvt_pk_bf16_f32 v232, v108, v109
    v_cvt_pk_bf16_f32 v233, v110, v111
    v_lshlrev_b32 v108, 16, v232
    v_and_b32 v109, 0xffff0000, v232
    v_lshlrev_b32 v110, 16, v233
    v_and_b32 v111, 0xffff0000, v233
    v_lshlrev_b32 v228, 16, v32
    v_and_b32 v229, 0xffff0000, v32
    v_lshlrev_b32 v230, 16, v33
    v_and_b32 v231, 0xffff0000, v33
    v_add_f32 v108, v108, v228
    v_add_f32 v109, v109, v229
    v_add_f32 v110, v110, v230
    v_add_f32 v111, v111, v231
    v_cvt_pk_bf16_f32 v232, v108, v109
    v_cvt_pk_bf16_f32 v233, v110, v111
    v_lshlrev_b32 v108, 16, v232
    v_and_b32 v109, 0xffff0000, v232
    v_lshlrev_b32 v110, 16, v233
    v_and_b32 v111, 0xffff0000, v233
    v_lshlrev_b32 v228, 16, v42
    v_and_b32 v229, 0xffff0000, v42
    v_lshlrev_b32 v230, 16, v43
    v_and_b32 v231, 0xffff0000, v43
    v_add_f32 v108, v108, v228
    v_add_f32 v109, v109, v229
    v_add_f32 v110, v110, v230
    v_add_f32 v111, v111, v231
    v_cvt_pk_bf16_f32 v112, v108, v109
    v_cvt_pk_bf16_f32 v113, v110, v111
    buffer_store_dwordx2 v[112:113], v22, s[20:23], 0 offen sc0 sc1
K3_END:
    s_endpgm
.section .rodata,"a"
.p2align 6
.amdhsa_kernel k0_kernel
  .amdhsa_next_free_vgpr 256
  .amdhsa_next_free_sgpr 102
  .amdhsa_accum_offset 256
  .amdhsa_group_segment_fixed_size 0
  .amdhsa_kernarg_size 96
  .amdhsa_user_sgpr_count 2
  .amdhsa_user_sgpr_kernarg_segment_ptr 1
  .amdhsa_system_sgpr_workgroup_id_x 1
.end_amdhsa_kernel
.p2align 6
.amdhsa_kernel k1_kernel
  .amdhsa_next_free_vgpr 416
  .amdhsa_next_free_sgpr 102
  .amdhsa_accum_offset 256
  .amdhsa_group_segment_fixed_size 0
  .amdhsa_kernarg_size 96
  .amdhsa_user_sgpr_count 2
  .amdhsa_user_sgpr_kernarg_segment_ptr 1
  .amdhsa_system_sgpr_workgroup_id_x 1
.end_amdhsa_kernel
.p2align 6
.amdhsa_kernel k2_kernel
  .amdhsa_next_free_vgpr 96
  .amdhsa_next_free_sgpr 102
  .amdhsa_accum_offset 96
  .amdhsa_group_segment_fixed_size 0
  .amdhsa_kernarg_size 96
  .amdhsa_user_sgpr_count 2
  .amdhsa_user_sgpr_kernarg_segment_ptr 1
  .amdhsa_system_sgpr_workgroup_id_x 1
.end_amdhsa_kernel
.p2align 6
.amdhsa_kernel k3_kernel
  .amdhsa_next_free_vgpr 512
  .amdhsa_next_free_sgpr 102
  .amdhsa_accum_offset 256
  .amdhsa_group_segment_fixed_size 0
  .amdhsa_kernarg_size 96
  .amdhsa_user_sgpr_count 2
  .amdhsa_user_sgpr_kernarg_segment_ptr 1
  .amdhsa_system_sgpr_workgroup_id_x 1
.end_amdhsa_kernel
```
